```python
import torch

def _softmax(x, axis=-1):
    return torch.softmax(x, dim=axis)
def _gelu(x):
    return torch.nn.functional.gelu(x, approximate="tanh")
def _silu(x):
    return torch.nn.functional.silu(x)
def _sigmoid(x):
    return torch.sigmoid(x)
def _layernorm(x, axis=-1, eps=1e-5):
    m = x.mean(dim=axis, keepdim=True)
    v = x.var(dim=axis, keepdim=True, unbiased=False)
    return (x - m) / torch.sqrt(v + eps)
def _scatter_add(tgt, idx, src, axis=0):
    return tgt.clone().index_add_(axis, idx, src)
def _segment_sum(src, seg, n):
    out = torch.zeros((n,) + src.shape[1:], dtype=src.dtype)
    return out.index_add_(0, seg, src)
def _pad(x, pw):
    flat = tuple(v for pair in reversed(pw) for v in pair)
    return torch.nn.functional.pad(x, flat)

kernel_name = 'sequential_preLN__sliding_block__moe_arch_mod__prompt'

def setup_inputs():

    _w = (lambda a: (lambda t: t.to(torch.bfloat16) if t.is_floating_point() else t)(torch.as_tensor(a)))
    def _A_setup():
        B, S, D = 1, 2048, 1024
        return {
            "x": _w((lambda *s: torch.randn(*s, dtype=torch.bfloat16) * 0.05)(B, S, D)),
            "wqkv": _w((lambda *s: torch.randn(*s, dtype=torch.bfloat16) * 0.05)(D, 3 * D)),
            "wo": _w((lambda *s: torch.randn(*s, dtype=torch.bfloat16) * 0.05)(D, D)),
        }
    _A_in = _A_setup()

    def _B_setup():
        B, S, D, F, C = 1, 2048, 1024, 3584, 2
        return {
            "x": _w((lambda *s: torch.randn(*s, dtype=torch.bfloat16) * 0.05)(B, S, D)),
            "w_r": _w((lambda *s: torch.randn(*s, dtype=torch.bfloat16) * 0.05)(D)),
            "w_gate": _w((lambda *s: torch.randn(*s, dtype=torch.bfloat16) * 0.05)(D, F)),
            "w_up": _w((lambda *s: torch.randn(*s, dtype=torch.bfloat16) * 0.05)(D, F)),
            "w_down": _w((lambda *s: torch.randn(*s, dtype=torch.bfloat16) * 0.05)(F, D)),
        }
    _B_in = _B_setup()

    return {
        "A_x": _A_in["x"],
        "A_wqkv": _A_in["wqkv"],
        "A_wo": _A_in["wo"],
        "B_x": _B_in["x"],
        "B_w_r": _B_in["w_r"],
        "B_w_gate": _B_in["w_gate"],
        "B_w_up": _B_in["w_up"],
        "B_w_down": _B_in["w_down"],
    }

def reference(A_x, A_wqkv, A_wo, B_x, B_w_r, B_w_gate, B_w_up, B_w_down):
    def _A_ref(x, wqkv, wo):
        B, S, D = x.shape
        H = 32; Dh = D // H; W = 256
        qkv = (lambda x, *d: x.permute(*d))((x @ wqkv).reshape(B, S, 3, H, Dh), 2, 0, 3, 1, 4)
        q, k, v = qkv[0], qkv[1], qkv[2]
        scores = torch.einsum("bhqd,bhkd->bhqk", q, k) * (Dh ** -0.5)
        idx = torch.arange(S)
        mask = (idx[:, None] - idx[None, :] >= 0) & (idx[:, None] - idx[None, :] < W)
        scores = torch.where(mask[None, None], scores, -1e9)
        p = _softmax(scores, axis=-1)
        o = torch.einsum("bhqk,bhkd->bhqd", p, v)
        return (lambda x, *d: x.permute(*d))(o, 0, 2, 1, 3).reshape(B, S, D) @ wo

    def _B_ref(x, w_r, w_gate, w_up, w_down):
        B, S, D = x.shape
        C = 2
        r = x @ w_r
        idx = torch.argsort(-r, axis=-1)[:, :C]
        idx_e = (lambda x, n, axis: torch.repeat_interleave(x, n, dim=axis))(idx.reshape(B, C, 1), D, axis=2)
        x_sel = (lambda x, i, axis: torch.take_along_dim(x, i, dim=axis))(x, idx_e, axis=1)
        g = _silu(x_sel @ w_gate)
        u = x_sel @ w_up
        y = (g * u) @ w_down
        r_sel = _sigmoid((lambda x, i, axis: torch.take_along_dim(x, i, dim=axis))(r, idx, axis=1))
        y = y * r_sel.reshape(B, C, 1)
        b_off = (torch.arange(B) * S).reshape(B, 1)
        flat_idx = (idx + b_off).reshape(B * C)
        zero = (x * 0.0).reshape(B * S, D)
        upd = _scatter_add(zero, flat_idx, y.reshape(B * C, D), axis=0)
        return x + upd.reshape(B, S, D)

    x = A_x
    h = x + _A_ref(_layernorm(x, axis=-1), A_wqkv, A_wo)
    h2 = h + _B_ref(_layernorm(h, axis=-1), B_w_r, B_w_gate, B_w_up, B_w_down)
    return h2
```

```asm
; @launch grid=(256,1,1) block=(512,1,1) lds=163840
.amdgcn_target "amdgcn-amd-amdhsa--gfx950"
.text
.globl sequential_preLN__sliding_block__moe_arch_mod__prompt_kernel
.p2align 8
.type sequential_preLN__sliding_block__moe_arch_mod__prompt_kernel,@function
sequential_preLN__sliding_block__moe_arch_mod__prompt_kernel:
    s_cmp_ge_u32 s2, 256
    s_cbranch_scc1 L_end
    s_load_dwordx2 s[4:5], s[0:1], 0
    s_load_dwordx2 s[8:9], s[0:1], 8
    s_load_dwordx2 s[12:13], s[0:1], 80
    s_load_dwordx2 s[24:25], s[0:1], 72
    s_load_dwordx2 s[16:17], s[0:1], 64
    v_lshrrev_b32 v2, 6, v0
    v_and_b32 v1, 63, v0
    v_readfirstlane_b32 s28, v2
    s_mov_b32 s6, 4194304
    s_mov_b32 s7, 0x20000
    s_mov_b32 s10, 6291456
    s_mov_b32 s11, 0x20000
    s_mov_b32 s14, 268435456
    s_mov_b32 s15, 0x20000
    s_mov_b32 s18, 4194304
    s_mov_b32 s19, 0x20000
    s_mov_b32 s54, 0
    s_and_b32 s30, s2, 7
    s_lshr_b32 s31, s2, 3
    s_and_b32 s26, s30, 1
    s_lshl_b32 s26, s26, 3
    s_and_b32 s32, s31, 7
    s_add_u32 s26, s26, s32
    s_lshr_b32 s27, s30, 1
    s_lshl_b32 s27, s27, 2
    s_lshr_b32 s32, s31, 3
    s_add_u32 s27, s27, s32
    s_lshl_b32 s34, s26, 4
    s_add_u32 s34, s34, s27
    s_and_b32 s29, s28, 3
    s_waitcnt lgkmcnt(0)
    s_cmp_ge_u32 s28, 4
    s_cbranch_scc1 L_g1_loader
    s_lshl_b32 s48, s34, 14
    s_mul_i32 s31, s29, 3072
    s_add_u32 s48, s48, s31
    s_add_u32 s48, s48, 12582912
    v_lshlrev_b32 v24, 4, v1
    v_lshlrev_b32 v33, 3, v1
    v_mov_b32 v4, -1
    v_mov_b32 v5, -1
    v_mov_b32 v6, -1
    v_mov_b32 v7, -1
    s_mov_b32 s49, 17825792
    buffer_load_dword v30, off, s[12:15], s49 sc1
    v_and_b32 v2, 31, v1
    v_lshrrev_b32 v3, 5, v1
    v_lshrrev_b32 v25, 1, v2
    v_and_b32 v25, 7, v25
    s_and_b32 s30, s29, 1
    s_lshl_b32 s30, s30, 13
    v_lshlrev_b32 v26, 7, v2
    v_add_u32 v26, s30, v26
    v_add_u32 v27, 0, v3
    v_xor_b32 v27, v27, v25
    v_lshl_add_u32 v8, v27, 4, v26
    v_add_u32 v12, 40960, v8
    v_add_u32 v16, 81920, v8
    v_add_u32 v27, 2, v3
    v_xor_b32 v27, v27, v25
    v_lshl_add_u32 v9, v27, 4, v26
    v_add_u32 v13, 40960, v9
    v_add_u32 v17, 81920, v9
    v_add_u32 v27, 4, v3
    v_xor_b32 v27, v27, v25
    v_lshl_add_u32 v10, v27, 4, v26
    v_add_u32 v14, 40960, v10
    v_add_u32 v18, 81920, v10
    v_add_u32 v27, 6, v3
    v_xor_b32 v27, v27, v25
    v_lshl_add_u32 v11, v27, 4, v26
    v_add_u32 v15, 40960, v11
    v_add_u32 v19, 81920, v11
    v_lshrrev_b32 v25, 4, v1
    v_and_b32 v26, 1, v25
    v_and_b32 v27, 15, v1
    v_lshrrev_b32 v28, 2, v27
    v_lshrrev_b32 v29, 1, v28
    v_lshl_add_u32 v28, v3, 3, v28
    v_mul_u32_u24 v28, 384, v28
    s_lshr_b32 s30, s29, 1
    v_xor_b32 v29, s30, v29
    v_lshl_add_u32 v28, v29, 6, v28
    v_and_b32 v27, 3, v1
    v_lshlrev_b32 v27, 3, v27
    v_lshl_add_u32 v27, v26, 5, v27
    v_add_u32 v28, v28, v27
    v_add_u32 v20, 16384, v28
    v_add_u32 v21, 57344, v28
    v_add_u32 v22, 98304, v28
    s_setprio 1
    s_barrier
    ds_read_b128 v[64:67], v8
    ds_read_b64_tr_b16 v[72:73], v20 offset:0
    ds_read_b64_tr_b16 v[74:75], v20 offset:1536
    ds_read_b128 v[68:71], v8 offset:4096
    ds_read_b64_tr_b16 v[76:77], v20 offset:128
    ds_read_b64_tr_b16 v[78:79], v20 offset:1664
    ds_read_b64_tr_b16 v[80:81], v20 offset:256
    ds_read_b64_tr_b16 v[82:83], v20 offset:1792
    s_waitcnt lgkmcnt(0)
    v_mfma_f32_32x32x16_bf16 v[128:143], v[72:75], v[64:67], 0
    ds_read_b128 v[84:87], v9
    ds_read_b64_tr_b16 v[92:93], v20 offset:6144
    ds_read_b64_tr_b16 v[94:95], v20 offset:7680
    v_mfma_f32_32x32x16_bf16 v[176:191], v[72:75], v[68:71], 0
    ds_read_b128 v[88:91], v9 offset:4096
    ds_read_b64_tr_b16 v[96:97], v20 offset:6272
    ds_read_b64_tr_b16 v[98:99], v20 offset:7808
    v_mfma_f32_32x32x16_bf16 v[144:159], v[76:79], v[64:67], 0
    ds_read_b64_tr_b16 v[100:101], v20 offset:6400
    ds_read_b64_tr_b16 v[102:103], v20 offset:7936
    v_mfma_f32_32x32x16_bf16 v[192:207], v[76:79], v[68:71], 0
    v_mfma_f32_32x32x16_bf16 v[160:175], v[64:67], v[80:83], 0
    v_mfma_f32_32x32x16_bf16 v[208:223], v[68:71], v[80:83], 0
    s_waitcnt lgkmcnt(0)
    buffer_store_dwordx4 v[4:7], v24, s[12:15], s48 offen sc1
    buffer_store_dwordx4 v[4:7], v24, s[12:15], s48 offen offset:1024 sc1
    buffer_store_dwordx4 v[4:7], v24, s[12:15], s48 offen offset:2048 sc1
    v_mfma_f32_32x32x16_bf16 v[128:143], v[92:95], v[84:87], v[128:143]
    ds_read_b128 v[64:67], v10
    ds_read_b64_tr_b16 v[72:73], v20 offset:12288
    ds_read_b64_tr_b16 v[74:75], v20 offset:13824
    v_mfma_f32_32x32x16_bf16 v[176:191], v[92:95], v[88:91], v[176:191]
    ds_read_b128 v[68:71], v10 offset:4096
    ds_read_b64_tr_b16 v[76:77], v20 offset:12416
    ds_read_b64_tr_b16 v[78:79], v20 offset:13952
    v_mfma_f32_32x32x16_bf16 v[144:159], v[96:99], v[84:87], v[144:159]
    ds_read_b64_tr_b16 v[80:81], v20 offset:12544
    ds_read_b64_tr_b16 v[82:83], v20 offset:14080
    v_mfma_f32_32x32x16_bf16 v[192:207], v[96:99], v[88:91], v[192:207]
    v_mfma_f32_32x32x16_bf16 v[160:175], v[84:87], v[100:103], v[160:175]
    v_mfma_f32_32x32x16_bf16 v[208:223], v[88:91], v[100:103], v[208:223]
    s_waitcnt lgkmcnt(0)
    s_or_b32 s30, s2, s28
    s_cmp_lg_u32 s30, 0
    s_cbranch_scc1 L_nonce_1
    s_waitcnt vmcnt(3)
    v_add_u32 v30, 1, v30
    v_max_u32 v30, 1, v30
    v_mov_b32 v31, 0
    v_cmp_eq_u32 vcc, 0, v1
    s_and_saveexec_b64 s[46:47], vcc
    global_store_dword v31, v30, s[24:25] sc1
    buffer_store_dword v30, off, s[12:15], s49 sc1
    s_mov_b64 exec, s[46:47]
L_nonce_1:
    v_mfma_f32_32x32x16_bf16 v[128:143], v[72:75], v[64:67], v[128:143]
    ds_read_b128 v[84:87], v11
    ds_read_b64_tr_b16 v[92:93], v20 offset:18432
    ds_read_b64_tr_b16 v[94:95], v20 offset:19968
    v_mfma_f32_32x32x16_bf16 v[176:191], v[72:75], v[68:71], v[176:191]
    ds_read_b128 v[88:91], v11 offset:4096
    ds_read_b64_tr_b16 v[96:97], v20 offset:18560
    ds_read_b64_tr_b16 v[98:99], v20 offset:20096
    v_mfma_f32_32x32x16_bf16 v[144:159], v[76:79], v[64:67], v[144:159]
    ds_read_b64_tr_b16 v[100:101], v20 offset:18688
    ds_read_b64_tr_b16 v[102:103], v20 offset:20224
    v_mfma_f32_32x32x16_bf16 v[192:207], v[76:79], v[68:71], v[192:207]
    v_mfma_f32_32x32x16_bf16 v[160:175], v[64:67], v[80:83], v[160:175]
    v_mfma_f32_32x32x16_bf16 v[208:223], v[68:71], v[80:83], v[208:223]
    s_waitcnt lgkmcnt(0)
    v_mfma_f32_32x32x16_bf16 v[128:143], v[92:95], v[84:87], v[128:143]
    v_mfma_f32_32x32x16_bf16 v[176:191], v[92:95], v[88:91], v[176:191]
    s_barrier
    ds_read_b128 v[64:67], v12
    ds_read_b64_tr_b16 v[72:73], v21 offset:0
    ds_read_b64_tr_b16 v[74:75], v21 offset:1536
    v_mfma_f32_32x32x16_bf16 v[144:159], v[96:99], v[84:87], v[144:159]
    ds_read_b128 v[68:71], v12 offset:4096
    ds_read_b64_tr_b16 v[76:77], v21 offset:128
    ds_read_b64_tr_b16 v[78:79], v21 offset:1664
    v_mfma_f32_32x32x16_bf16 v[192:207], v[96:99], v[88:91], v[192:207]
    ds_read_b64_tr_b16 v[80:81], v21 offset:256
    ds_read_b64_tr_b16 v[82:83], v21 offset:1792
    v_mfma_f32_32x32x16_bf16 v[160:175], v[84:87], v[100:103], v[160:175]
    v_mfma_f32_32x32x16_bf16 v[208:223], v[88:91], v[100:103], v[208:223]
    s_waitcnt lgkmcnt(0)
    v_mfma_f32_32x32x16_bf16 v[128:143], v[72:75], v[64:67], v[128:143]
    ds_read_b128 v[84:87], v13
    ds_read_b64_tr_b16 v[92:93], v21 offset:6144
    ds_read_b64_tr_b16 v[94:95], v21 offset:7680
    v_mfma_f32_32x32x16_bf16 v[176:191], v[72:75], v[68:71], v[176:191]
    ds_read_b128 v[88:91], v13 offset:4096
    ds_read_b64_tr_b16 v[96:97], v21 offset:6272
    ds_read_b64_tr_b16 v[98:99], v21 offset:7808
    v_mfma_f32_32x32x16_bf16 v[144:159], v[76:79], v[64:67], v[144:159]
    ds_read_b64_tr_b16 v[100:101], v21 offset:6400
    ds_read_b64_tr_b16 v[102:103], v21 offset:7936
    v_mfma_f32_32x32x16_bf16 v[192:207], v[76:79], v[68:71], v[192:207]
    v_mfma_f32_32x32x16_bf16 v[160:175], v[64:67], v[80:83], v[160:175]
    v_mfma_f32_32x32x16_bf16 v[208:223], v[68:71], v[80:83], v[208:223]
    s_waitcnt lgkmcnt(0)
    v_mfma_f32_32x32x16_bf16 v[128:143], v[92:95], v[84:87], v[128:143]
    ds_read_b128 v[64:67], v14
    ds_read_b64_tr_b16 v[72:73], v21 offset:12288
    ds_read_b64_tr_b16 v[74:75], v21 offset:13824
    v_mfma_f32_32x32x16_bf16 v[176:191], v[92:95], v[88:91], v[176:191]
    ds_read_b128 v[68:71], v14 offset:4096
    ds_read_b64_tr_b16 v[76:77], v21 offset:12416
    ds_read_b64_tr_b16 v[78:79], v21 offset:13952
    v_mfma_f32_32x32x16_bf16 v[144:159], v[96:99], v[84:87], v[144:159]
    ds_read_b64_tr_b16 v[80:81], v21 offset:12544
    ds_read_b64_tr_b16 v[82:83], v21 offset:14080
    v_mfma_f32_32x32x16_bf16 v[192:207], v[96:99], v[88:91], v[192:207]
    v_mfma_f32_32x32x16_bf16 v[160:175], v[84:87], v[100:103], v[160:175]
    v_mfma_f32_32x32x16_bf16 v[208:223], v[88:91], v[100:103], v[208:223]
    s_waitcnt lgkmcnt(0)
    v_mfma_f32_32x32x16_bf16 v[128:143], v[72:75], v[64:67], v[128:143]
    ds_read_b128 v[84:87], v15
    ds_read_b64_tr_b16 v[92:93], v21 offset:18432
    ds_read_b64_tr_b16 v[94:95], v21 offset:19968
    v_mfma_f32_32x32x16_bf16 v[176:191], v[72:75], v[68:71], v[176:191]
    ds_read_b128 v[88:91], v15 offset:4096
    ds_read_b64_tr_b16 v[96:97], v21 offset:18560
    ds_read_b64_tr_b16 v[98:99], v21 offset:20096
    v_mfma_f32_32x32x16_bf16 v[144:159], v[76:79], v[64:67], v[144:159]
    ds_read_b64_tr_b16 v[100:101], v21 offset:18688
    ds_read_b64_tr_b16 v[102:103], v21 offset:20224
    v_mfma_f32_32x32x16_bf16 v[192:207], v[76:79], v[68:71], v[192:207]
    v_mfma_f32_32x32x16_bf16 v[160:175], v[64:67], v[80:83], v[160:175]
    v_mfma_f32_32x32x16_bf16 v[208:223], v[68:71], v[80:83], v[208:223]
    s_waitcnt lgkmcnt(0)
    v_mfma_f32_32x32x16_bf16 v[128:143], v[92:95], v[84:87], v[128:143]
    v_mfma_f32_32x32x16_bf16 v[176:191], v[92:95], v[88:91], v[176:191]
    s_barrier
    ds_read_b128 v[64:67], v16
    ds_read_b64_tr_b16 v[72:73], v22 offset:0
    ds_read_b64_tr_b16 v[74:75], v22 offset:1536
    v_mfma_f32_32x32x16_bf16 v[144:159], v[96:99], v[84:87], v[144:159]
    ds_read_b128 v[68:71], v16 offset:4096
    ds_read_b64_tr_b16 v[76:77], v22 offset:128
    ds_read_b64_tr_b16 v[78:79], v22 offset:1664
    v_mfma_f32_32x32x16_bf16 v[192:207], v[96:99], v[88:91], v[192:207]
    ds_read_b64_tr_b16 v[80:81], v22 offset:256
    ds_read_b64_tr_b16 v[82:83], v22 offset:1792
    v_mfma_f32_32x32x16_bf16 v[160:175], v[84:87], v[100:103], v[160:175]
    v_mfma_f32_32x32x16_bf16 v[208:223], v[88:91], v[100:103], v[208:223]
    s_waitcnt lgkmcnt(0)
    v_mfma_f32_32x32x16_bf16 v[128:143], v[72:75], v[64:67], v[128:143]
    ds_read_b128 v[84:87], v17
    ds_read_b64_tr_b16 v[92:93], v22 offset:6144
    ds_read_b64_tr_b16 v[94:95], v22 offset:7680
    v_mfma_f32_32x32x16_bf16 v[176:191], v[72:75], v[68:71], v[176:191]
    ds_read_b128 v[88:91], v17 offset:4096
    ds_read_b64_tr_b16 v[96:97], v22 offset:6272
    ds_read_b64_tr_b16 v[98:99], v22 offset:7808
    v_mfma_f32_32x32x16_bf16 v[144:159], v[76:79], v[64:67], v[144:159]
    ds_read_b64_tr_b16 v[100:101], v22 offset:6400
    ds_read_b64_tr_b16 v[102:103], v22 offset:7936
    v_mfma_f32_32x32x16_bf16 v[192:207], v[76:79], v[68:71], v[192:207]
    v_mfma_f32_32x32x16_bf16 v[160:175], v[64:67], v[80:83], v[160:175]
    v_mfma_f32_32x32x16_bf16 v[208:223], v[68:71], v[80:83], v[208:223]
    s_waitcnt lgkmcnt(0)
    v_mfma_f32_32x32x16_bf16 v[128:143], v[92:95], v[84:87], v[128:143]
    ds_read_b128 v[64:67], v18
    ds_read_b64_tr_b16 v[72:73], v22 offset:12288
    ds_read_b64_tr_b16 v[74:75], v22 offset:13824
    v_mfma_f32_32x32x16_bf16 v[176:191], v[92:95], v[88:91], v[176:191]
    ds_read_b128 v[68:71], v18 offset:4096
    ds_read_b64_tr_b16 v[76:77], v22 offset:12416
    ds_read_b64_tr_b16 v[78:79], v22 offset:13952
    v_mfma_f32_32x32x16_bf16 v[144:159], v[96:99], v[84:87], v[144:159]
    ds_read_b64_tr_b16 v[80:81], v22 offset:12544
    ds_read_b64_tr_b16 v[82:83], v22 offset:14080
    v_mfma_f32_32x32x16_bf16 v[192:207], v[96:99], v[88:91], v[192:207]
    v_mfma_f32_32x32x16_bf16 v[160:175], v[84:87], v[100:103], v[160:175]
    v_mfma_f32_32x32x16_bf16 v[208:223], v[88:91], v[100:103], v[208:223]
    s_waitcnt lgkmcnt(0)
    v_mfma_f32_32x32x16_bf16 v[128:143], v[72:75], v[64:67], v[128:143]
    ds_read_b128 v[84:87], v19
    ds_read_b64_tr_b16 v[92:93], v22 offset:18432
    ds_read_b64_tr_b16 v[94:95], v22 offset:19968
    v_mfma_f32_32x32x16_bf16 v[176:191], v[72:75], v[68:71], v[176:191]
    ds_read_b128 v[88:91], v19 offset:4096
    ds_read_b64_tr_b16 v[96:97], v22 offset:18560
    ds_read_b64_tr_b16 v[98:99], v22 offset:20096
    v_mfma_f32_32x32x16_bf16 v[144:159], v[76:79], v[64:67], v[144:159]
    ds_read_b64_tr_b16 v[100:101], v22 offset:18688
    ds_read_b64_tr_b16 v[102:103], v22 offset:20224
    v_mfma_f32_32x32x16_bf16 v[192:207], v[76:79], v[68:71], v[192:207]
    v_mfma_f32_32x32x16_bf16 v[160:175], v[64:67], v[80:83], v[160:175]
    v_mfma_f32_32x32x16_bf16 v[208:223], v[68:71], v[80:83], v[208:223]
    s_waitcnt lgkmcnt(0)
    v_mfma_f32_32x32x16_bf16 v[128:143], v[92:95], v[84:87], v[128:143]
    v_mfma_f32_32x32x16_bf16 v[176:191], v[92:95], v[88:91], v[176:191]
    s_barrier
    ds_read_b128 v[64:67], v8
    ds_read_b64_tr_b16 v[72:73], v20 offset:0
    ds_read_b64_tr_b16 v[74:75], v20 offset:1536
    v_mfma_f32_32x32x16_bf16 v[144:159], v[96:99], v[84:87], v[144:159]
    ds_read_b128 v[68:71], v8 offset:4096
    ds_read_b64_tr_b16 v[76:77], v20 offset:128
    ds_read_b64_tr_b16 v[78:79], v20 offset:1664
    v_mfma_f32_32x32x16_bf16 v[192:207], v[96:99], v[88:91], v[192:207]
    ds_read_b64_tr_b16 v[80:81], v20 offset:256
    ds_read_b64_tr_b16 v[82:83], v20 offset:1792
    v_mfma_f32_32x32x16_bf16 v[160:175], v[84:87], v[100:103], v[160:175]
    v_mfma_f32_32x32x16_bf16 v[208:223], v[88:91], v[100:103], v[208:223]
    s_waitcnt lgkmcnt(0)
    v_mfma_f32_32x32x16_bf16 v[128:143], v[72:75], v[64:67], v[128:143]
    ds_read_b128 v[84:87], v9
    ds_read_b64_tr_b16 v[92:93], v20 offset:6144
    ds_read_b64_tr_b16 v[94:95], v20 offset:7680
    v_mfma_f32_32x32x16_bf16 v[176:191], v[72:75], v[68:71], v[176:191]
    ds_read_b128 v[88:91], v9 offset:4096
    ds_read_b64_tr_b16 v[96:97], v20 offset:6272
    ds_read_b64_tr_b16 v[98:99], v20 offset:7808
    v_mfma_f32_32x32x16_bf16 v[144:159], v[76:79], v[64:67], v[144:159]
    ds_read_b64_tr_b16 v[100:101], v20 offset:6400
    ds_read_b64_tr_b16 v[102:103], v20 offset:7936
    v_mfma_f32_32x32x16_bf16 v[192:207], v[76:79], v[68:71], v[192:207]
    v_mfma_f32_32x32x16_bf16 v[160:175], v[64:67], v[80:83], v[160:175]
    v_mfma_f32_32x32x16_bf16 v[208:223], v[68:71], v[80:83], v[208:223]
    s_waitcnt lgkmcnt(0)
    v_mfma_f32_32x32x16_bf16 v[128:143], v[92:95], v[84:87], v[128:143]
    ds_read_b128 v[64:67], v10
    ds_read_b64_tr_b16 v[72:73], v20 offset:12288
    ds_read_b64_tr_b16 v[74:75], v20 offset:13824
    v_mfma_f32_32x32x16_bf16 v[176:191], v[92:95], v[88:91], v[176:191]
    ds_read_b128 v[68:71], v10 offset:4096
    ds_read_b64_tr_b16 v[76:77], v20 offset:12416
    ds_read_b64_tr_b16 v[78:79], v20 offset:13952
    v_mfma_f32_32x32x16_bf16 v[144:159], v[96:99], v[84:87], v[144:159]
    ds_read_b64_tr_b16 v[80:81], v20 offset:12544
    ds_read_b64_tr_b16 v[82:83], v20 offset:14080
    v_mfma_f32_32x32x16_bf16 v[192:207], v[96:99], v[88:91], v[192:207]
    v_mfma_f32_32x32x16_bf16 v[160:175], v[84:87], v[100:103], v[160:175]
    v_mfma_f32_32x32x16_bf16 v[208:223], v[88:91], v[100:103], v[208:223]
    s_waitcnt lgkmcnt(0)
    v_mfma_f32_32x32x16_bf16 v[128:143], v[72:75], v[64:67], v[128:143]
    ds_read_b128 v[84:87], v11
    ds_read_b64_tr_b16 v[92:93], v20 offset:18432
    ds_read_b64_tr_b16 v[94:95], v20 offset:19968
    v_mfma_f32_32x32x16_bf16 v[176:191], v[72:75], v[68:71], v[176:191]
    ds_read_b128 v[88:91], v11 offset:4096
    ds_read_b64_tr_b16 v[96:97], v20 offset:18560
    ds_read_b64_tr_b16 v[98:99], v20 offset:20096
    v_mfma_f32_32x32x16_bf16 v[144:159], v[76:79], v[64:67], v[144:159]
    ds_read_b64_tr_b16 v[100:101], v20 offset:18688
    ds_read_b64_tr_b16 v[102:103], v20 offset:20224
    v_mfma_f32_32x32x16_bf16 v[192:207], v[76:79], v[68:71], v[192:207]
    v_mfma_f32_32x32x16_bf16 v[160:175], v[64:67], v[80:83], v[160:175]
    v_mfma_f32_32x32x16_bf16 v[208:223], v[68:71], v[80:83], v[208:223]
    s_waitcnt vmcnt(0) lgkmcnt(0)
    v_mfma_f32_32x32x16_bf16 v[128:143], v[92:95], v[84:87], v[128:143]
    v_mfma_f32_32x32x16_bf16 v[176:191], v[92:95], v[88:91], v[176:191]
    s_barrier
    ds_read_b128 v[64:67], v12
    ds_read_b64_tr_b16 v[72:73], v21 offset:0
    ds_read_b64_tr_b16 v[74:75], v21 offset:1536
    v_mfma_f32_32x32x16_bf16 v[144:159], v[96:99], v[84:87], v[144:159]
    ds_read_b128 v[68:71], v12 offset:4096
    ds_read_b64_tr_b16 v[76:77], v21 offset:128
    ds_read_b64_tr_b16 v[78:79], v21 offset:1664
    v_mfma_f32_32x32x16_bf16 v[192:207], v[96:99], v[88:91], v[192:207]
    ds_read_b64_tr_b16 v[80:81], v21 offset:256
    ds_read_b64_tr_b16 v[82:83], v21 offset:1792
    v_mfma_f32_32x32x16_bf16 v[160:175], v[84:87], v[100:103], v[160:175]
    v_mfma_f32_32x32x16_bf16 v[208:223], v[88:91], v[100:103], v[208:223]
    s_waitcnt lgkmcnt(0)
    v_mfma_f32_32x32x16_bf16 v[128:143], v[72:75], v[64:67], v[128:143]
    ds_read_b128 v[84:87], v13
    ds_read_b64_tr_b16 v[92:93], v21 offset:6144
    ds_read_b64_tr_b16 v[94:95], v21 offset:7680
    v_mfma_f32_32x32x16_bf16 v[176:191], v[72:75], v[68:71], v[176:191]
    ds_read_b128 v[88:91], v13 offset:4096
    ds_read_b64_tr_b16 v[96:97], v21 offset:6272
    ds_read_b64_tr_b16 v[98:99], v21 offset:7808
    v_mfma_f32_32x32x16_bf16 v[144:159], v[76:79], v[64:67], v[144:159]
    ds_read_b64_tr_b16 v[100:101], v21 offset:6400
    ds_read_b64_tr_b16 v[102:103], v21 offset:7936
    v_mfma_f32_32x32x16_bf16 v[192:207], v[76:79], v[68:71], v[192:207]
    v_mfma_f32_32x32x16_bf16 v[160:175], v[64:67], v[80:83], v[160:175]
    v_mfma_f32_32x32x16_bf16 v[208:223], v[68:71], v[80:83], v[208:223]
    s_waitcnt lgkmcnt(0)
    v_mfma_f32_32x32x16_bf16 v[128:143], v[92:95], v[84:87], v[128:143]
    ds_read_b128 v[64:67], v14
    ds_read_b64_tr_b16 v[72:73], v21 offset:12288
    ds_read_b64_tr_b16 v[74:75], v21 offset:13824
    v_mfma_f32_32x32x16_bf16 v[176:191], v[92:95], v[88:91], v[176:191]
    ds_read_b128 v[68:71], v14 offset:4096
    ds_read_b64_tr_b16 v[76:77], v21 offset:12416
    ds_read_b64_tr_b16 v[78:79], v21 offset:13952
    v_mfma_f32_32x32x16_bf16 v[144:159], v[96:99], v[84:87], v[144:159]
    ds_read_b64_tr_b16 v[80:81], v21 offset:12544
    ds_read_b64_tr_b16 v[82:83], v21 offset:14080
    v_mfma_f32_32x32x16_bf16 v[192:207], v[96:99], v[88:91], v[192:207]
    v_mfma_f32_32x32x16_bf16 v[160:175], v[84:87], v[100:103], v[160:175]
    v_mfma_f32_32x32x16_bf16 v[208:223], v[88:91], v[100:103], v[208:223]
    s_waitcnt lgkmcnt(0)
    v_mfma_f32_32x32x16_bf16 v[128:143], v[72:75], v[64:67], v[128:143]
    ds_read_b128 v[84:87], v15
    ds_read_b64_tr_b16 v[92:93], v21 offset:18432
    ds_read_b64_tr_b16 v[94:95], v21 offset:19968
    v_mfma_f32_32x32x16_bf16 v[176:191], v[72:75], v[68:71], v[176:191]
    ds_read_b128 v[88:91], v15 offset:4096
    ds_read_b64_tr_b16 v[96:97], v21 offset:18560
    ds_read_b64_tr_b16 v[98:99], v21 offset:20096
    v_mfma_f32_32x32x16_bf16 v[144:159], v[76:79], v[64:67], v[144:159]
    ds_read_b64_tr_b16 v[100:101], v21 offset:18688
    ds_read_b64_tr_b16 v[102:103], v21 offset:20224
    v_mfma_f32_32x32x16_bf16 v[192:207], v[76:79], v[68:71], v[192:207]
    v_mfma_f32_32x32x16_bf16 v[160:175], v[64:67], v[80:83], v[160:175]
    v_mfma_f32_32x32x16_bf16 v[208:223], v[68:71], v[80:83], v[208:223]
    s_waitcnt lgkmcnt(0)
    v_mfma_f32_32x32x16_bf16 v[128:143], v[92:95], v[84:87], v[128:143]
    v_mfma_f32_32x32x16_bf16 v[176:191], v[92:95], v[88:91], v[176:191]
    s_barrier
    ds_read_b128 v[64:67], v16
    ds_read_b64_tr_b16 v[72:73], v22 offset:0
    ds_read_b64_tr_b16 v[74:75], v22 offset:1536
    v_mfma_f32_32x32x16_bf16 v[144:159], v[96:99], v[84:87], v[144:159]
    ds_read_b128 v[68:71], v16 offset:4096
    ds_read_b64_tr_b16 v[76:77], v22 offset:128
    ds_read_b64_tr_b16 v[78:79], v22 offset:1664
    v_mfma_f32_32x32x16_bf16 v[192:207], v[96:99], v[88:91], v[192:207]
    ds_read_b64_tr_b16 v[80:81], v22 offset:256
    ds_read_b64_tr_b16 v[82:83], v22 offset:1792
    v_mfma_f32_32x32x16_bf16 v[160:175], v[84:87], v[100:103], v[160:175]
    v_mfma_f32_32x32x16_bf16 v[208:223], v[88:91], v[100:103], v[208:223]
    s_waitcnt lgkmcnt(0)
    v_mfma_f32_32x32x16_bf16 v[128:143], v[72:75], v[64:67], v[128:143]
    ds_read_b128 v[84:87], v17
    ds_read_b64_tr_b16 v[92:93], v22 offset:6144
    ds_read_b64_tr_b16 v[94:95], v22 offset:7680
    v_mfma_f32_32x32x16_bf16 v[176:191], v[72:75], v[68:71], v[176:191]
    ds_read_b128 v[88:91], v17 offset:4096
    ds_read_b64_tr_b16 v[96:97], v22 offset:6272
    ds_read_b64_tr_b16 v[98:99], v22 offset:7808
    v_mfma_f32_32x32x16_bf16 v[144:159], v[76:79], v[64:67], v[144:159]
    ds_read_b64_tr_b16 v[100:101], v22 offset:6400
    ds_read_b64_tr_b16 v[102:103], v22 offset:7936
    v_mfma_f32_32x32x16_bf16 v[192:207], v[76:79], v[68:71], v[192:207]
    v_mfma_f32_32x32x16_bf16 v[160:175], v[64:67], v[80:83], v[160:175]
    v_mfma_f32_32x32x16_bf16 v[208:223], v[68:71], v[80:83], v[208:223]
    s_waitcnt lgkmcnt(0)
    v_mfma_f32_32x32x16_bf16 v[128:143], v[92:95], v[84:87], v[128:143]
    ds_read_b128 v[64:67], v18
    ds_read_b64_tr_b16 v[72:73], v22 offset:12288
    ds_read_b64_tr_b16 v[74:75], v22 offset:13824
    v_mfma_f32_32x32x16_bf16 v[176:191], v[92:95], v[88:91], v[176:191]
    ds_read_b128 v[68:71], v18 offset:4096
    ds_read_b64_tr_b16 v[76:77], v22 offset:12416
    ds_read_b64_tr_b16 v[78:79], v22 offset:13952
    v_mfma_f32_32x32x16_bf16 v[144:159], v[96:99], v[84:87], v[144:159]
    ds_read_b64_tr_b16 v[80:81], v22 offset:12544
    ds_read_b64_tr_b16 v[82:83], v22 offset:14080
    v_mfma_f32_32x32x16_bf16 v[192:207], v[96:99], v[88:91], v[192:207]
    v_mfma_f32_32x32x16_bf16 v[160:175], v[84:87], v[100:103], v[160:175]
    v_mfma_f32_32x32x16_bf16 v[208:223], v[88:91], v[100:103], v[208:223]
    s_waitcnt lgkmcnt(0)
    v_mfma_f32_32x32x16_bf16 v[128:143], v[72:75], v[64:67], v[128:143]
    ds_read_b128 v[84:87], v19
    ds_read_b64_tr_b16 v[92:93], v22 offset:18432
    ds_read_b64_tr_b16 v[94:95], v22 offset:19968
    v_mfma_f32_32x32x16_bf16 v[176:191], v[72:75], v[68:71], v[176:191]
    ds_read_b128 v[88:91], v19 offset:4096
    ds_read_b64_tr_b16 v[96:97], v22 offset:18560
    ds_read_b64_tr_b16 v[98:99], v22 offset:20096
    v_mfma_f32_32x32x16_bf16 v[144:159], v[76:79], v[64:67], v[144:159]
    ds_read_b64_tr_b16 v[100:101], v22 offset:18688
    ds_read_b64_tr_b16 v[102:103], v22 offset:20224
    v_mfma_f32_32x32x16_bf16 v[192:207], v[76:79], v[68:71], v[192:207]
    v_mfma_f32_32x32x16_bf16 v[160:175], v[64:67], v[80:83], v[160:175]
    v_mfma_f32_32x32x16_bf16 v[208:223], v[68:71], v[80:83], v[208:223]
    s_waitcnt lgkmcnt(0)
    v_mfma_f32_32x32x16_bf16 v[128:143], v[92:95], v[84:87], v[128:143]
    v_mfma_f32_32x32x16_bf16 v[176:191], v[92:95], v[88:91], v[176:191]
    s_barrier
    ds_read_b128 v[64:67], v8
    ds_read_b64_tr_b16 v[72:73], v20 offset:0
    ds_read_b64_tr_b16 v[74:75], v20 offset:1536
    v_mfma_f32_32x32x16_bf16 v[144:159], v[96:99], v[84:87], v[144:159]
    ds_read_b128 v[68:71], v8 offset:4096
    ds_read_b64_tr_b16 v[76:77], v20 offset:128
    ds_read_b64_tr_b16 v[78:79], v20 offset:1664
    v_mfma_f32_32x32x16_bf16 v[192:207], v[96:99], v[88:91], v[192:207]
    ds_read_b64_tr_b16 v[80:81], v20 offset:256
    ds_read_b64_tr_b16 v[82:83], v20 offset:1792
    v_mfma_f32_32x32x16_bf16 v[160:175], v[84:87], v[100:103], v[160:175]
    v_mfma_f32_32x32x16_bf16 v[208:223], v[88:91], v[100:103], v[208:223]
    s_waitcnt lgkmcnt(0)
    v_mfma_f32_32x32x16_bf16 v[128:143], v[72:75], v[64:67], v[128:143]
    ds_read_b128 v[84:87], v9
    ds_read_b64_tr_b16 v[92:93], v20 offset:6144
    ds_read_b64_tr_b16 v[94:95], v20 offset:7680
    v_mfma_f32_32x32x16_bf16 v[176:191], v[72:75], v[68:71], v[176:191]
    ds_read_b128 v[88:91], v9 offset:4096
    ds_read_b64_tr_b16 v[96:97], v20 offset:6272
    ds_read_b64_tr_b16 v[98:99], v20 offset:7808
    v_mfma_f32_32x32x16_bf16 v[144:159], v[76:79], v[64:67], v[144:159]
    ds_read_b64_tr_b16 v[100:101], v20 offset:6400
    ds_read_b64_tr_b16 v[102:103], v20 offset:7936
    v_mfma_f32_32x32x16_bf16 v[192:207], v[76:79], v[68:71], v[192:207]
    v_mfma_f32_32x32x16_bf16 v[160:175], v[64:67], v[80:83], v[160:175]
    v_mfma_f32_32x32x16_bf16 v[208:223], v[68:71], v[80:83], v[208:223]
    s_waitcnt lgkmcnt(0)
    v_mfma_f32_32x32x16_bf16 v[128:143], v[92:95], v[84:87], v[128:143]
    ds_read_b128 v[64:67], v10
    ds_read_b64_tr_b16 v[72:73], v20 offset:12288
    ds_read_b64_tr_b16 v[74:75], v20 offset:13824
    v_mfma_f32_32x32x16_bf16 v[176:191], v[92:95], v[88:91], v[176:191]
    ds_read_b128 v[68:71], v10 offset:4096
    ds_read_b64_tr_b16 v[76:77], v20 offset:12416
    ds_read_b64_tr_b16 v[78:79], v20 offset:13952
    v_mfma_f32_32x32x16_bf16 v[144:159], v[96:99], v[84:87], v[144:159]
    ds_read_b64_tr_b16 v[80:81], v20 offset:12544
    ds_read_b64_tr_b16 v[82:83], v20 offset:14080
    v_mfma_f32_32x32x16_bf16 v[192:207], v[96:99], v[88:91], v[192:207]
    v_mfma_f32_32x32x16_bf16 v[160:175], v[84:87], v[100:103], v[160:175]
    v_mfma_f32_32x32x16_bf16 v[208:223], v[88:91], v[100:103], v[208:223]
    s_waitcnt lgkmcnt(0)
    v_mfma_f32_32x32x16_bf16 v[128:143], v[72:75], v[64:67], v[128:143]
    ds_read_b128 v[84:87], v11
    ds_read_b64_tr_b16 v[92:93], v20 offset:18432
    ds_read_b64_tr_b16 v[94:95], v20 offset:19968
    v_mfma_f32_32x32x16_bf16 v[176:191], v[72:75], v[68:71], v[176:191]
    ds_read_b128 v[88:91], v11 offset:4096
    ds_read_b64_tr_b16 v[96:97], v20 offset:18560
    ds_read_b64_tr_b16 v[98:99], v20 offset:20096
    v_mfma_f32_32x32x16_bf16 v[144:159], v[76:79], v[64:67], v[144:159]
    ds_read_b64_tr_b16 v[100:101], v20 offset:18688
    ds_read_b64_tr_b16 v[102:103], v20 offset:20224
    v_mfma_f32_32x32x16_bf16 v[192:207], v[76:79], v[68:71], v[192:207]
    v_mfma_f32_32x32x16_bf16 v[160:175], v[64:67], v[80:83], v[160:175]
    v_mfma_f32_32x32x16_bf16 v[208:223], v[68:71], v[80:83], v[208:223]
    s_waitcnt lgkmcnt(0)
    v_mfma_f32_32x32x16_bf16 v[128:143], v[92:95], v[84:87], v[128:143]
    v_mfma_f32_32x32x16_bf16 v[176:191], v[92:95], v[88:91], v[176:191]
    s_barrier
    ds_read_b128 v[64:67], v12
    ds_read_b64_tr_b16 v[72:73], v21 offset:0
    ds_read_b64_tr_b16 v[74:75], v21 offset:1536
    v_mfma_f32_32x32x16_bf16 v[144:159], v[96:99], v[84:87], v[144:159]
    ds_read_b128 v[68:71], v12 offset:4096
    ds_read_b64_tr_b16 v[76:77], v21 offset:128
    ds_read_b64_tr_b16 v[78:79], v21 offset:1664
    v_mfma_f32_32x32x16_bf16 v[192:207], v[96:99], v[88:91], v[192:207]
    ds_read_b64_tr_b16 v[80:81], v21 offset:256
    ds_read_b64_tr_b16 v[82:83], v21 offset:1792
    v_mfma_f32_32x32x16_bf16 v[160:175], v[84:87], v[100:103], v[160:175]
    v_mfma_f32_32x32x16_bf16 v[208:223], v[88:91], v[100:103], v[208:223]
    s_waitcnt lgkmcnt(0)
    v_mfma_f32_32x32x16_bf16 v[128:143], v[72:75], v[64:67], v[128:143]
    ds_read_b128 v[84:87], v13
    ds_read_b64_tr_b16 v[92:93], v21 offset:6144
    ds_read_b64_tr_b16 v[94:95], v21 offset:7680
    v_mfma_f32_32x32x16_bf16 v[176:191], v[72:75], v[68:71], v[176:191]
    ds_read_b128 v[88:91], v13 offset:4096
    ds_read_b64_tr_b16 v[96:97], v21 offset:6272
    ds_read_b64_tr_b16 v[98:99], v21 offset:7808
    v_mfma_f32_32x32x16_bf16 v[144:159], v[76:79], v[64:67], v[144:159]
    ds_read_b64_tr_b16 v[100:101], v21 offset:6400
    ds_read_b64_tr_b16 v[102:103], v21 offset:7936
    v_mfma_f32_32x32x16_bf16 v[192:207], v[76:79], v[68:71], v[192:207]
    v_mfma_f32_32x32x16_bf16 v[160:175], v[64:67], v[80:83], v[160:175]
    v_mfma_f32_32x32x16_bf16 v[208:223], v[68:71], v[80:83], v[208:223]
    s_waitcnt lgkmcnt(0)
    v_mfma_f32_32x32x16_bf16 v[128:143], v[92:95], v[84:87], v[128:143]
    ds_read_b128 v[64:67], v14
    ds_read_b64_tr_b16 v[72:73], v21 offset:12288
    ds_read_b64_tr_b16 v[74:75], v21 offset:13824
    v_mfma_f32_32x32x16_bf16 v[176:191], v[92:95], v[88:91], v[176:191]
    ds_read_b128 v[68:71], v14 offset:4096
    ds_read_b64_tr_b16 v[76:77], v21 offset:12416
    ds_read_b64_tr_b16 v[78:79], v21 offset:13952
    v_mfma_f32_32x32x16_bf16 v[144:159], v[96:99], v[84:87], v[144:159]
    ds_read_b64_tr_b16 v[80:81], v21 offset:12544
    ds_read_b64_tr_b16 v[82:83], v21 offset:14080
    v_mfma_f32_32x32x16_bf16 v[192:207], v[96:99], v[88:91], v[192:207]
    v_mfma_f32_32x32x16_bf16 v[160:175], v[84:87], v[100:103], v[160:175]
    v_mfma_f32_32x32x16_bf16 v[208:223], v[88:91], v[100:103], v[208:223]
    s_waitcnt lgkmcnt(0)
    v_mfma_f32_32x32x16_bf16 v[128:143], v[72:75], v[64:67], v[128:143]
    ds_read_b128 v[84:87], v15
    ds_read_b64_tr_b16 v[92:93], v21 offset:18432
    ds_read_b64_tr_b16 v[94:95], v21 offset:19968
    v_mfma_f32_32x32x16_bf16 v[176:191], v[72:75], v[68:71], v[176:191]
    ds_read_b128 v[88:91], v15 offset:4096
    ds_read_b64_tr_b16 v[96:97], v21 offset:18560
    ds_read_b64_tr_b16 v[98:99], v21 offset:20096
    v_mfma_f32_32x32x16_bf16 v[144:159], v[76:79], v[64:67], v[144:159]
    ds_read_b64_tr_b16 v[100:101], v21 offset:18688
    ds_read_b64_tr_b16 v[102:103], v21 offset:20224
    v_mfma_f32_32x32x16_bf16 v[192:207], v[76:79], v[68:71], v[192:207]
    v_mfma_f32_32x32x16_bf16 v[160:175], v[64:67], v[80:83], v[160:175]
    v_mfma_f32_32x32x16_bf16 v[208:223], v[68:71], v[80:83], v[208:223]
    s_waitcnt lgkmcnt(0)
    v_mfma_f32_32x32x16_bf16 v[128:143], v[92:95], v[84:87], v[128:143]
    v_mfma_f32_32x32x16_bf16 v[176:191], v[92:95], v[88:91], v[176:191]
    s_barrier
    ds_read_b128 v[64:67], v16
    ds_read_b64_tr_b16 v[72:73], v22 offset:0
    ds_read_b64_tr_b16 v[74:75], v22 offset:1536
    v_mfma_f32_32x32x16_bf16 v[144:159], v[96:99], v[84:87], v[144:159]
    ds_read_b128 v[68:71], v16 offset:4096
    ds_read_b64_tr_b16 v[76:77], v22 offset:128
    ds_read_b64_tr_b16 v[78:79], v22 offset:1664
    v_mfma_f32_32x32x16_bf16 v[192:207], v[96:99], v[88:91], v[192:207]
    ds_read_b64_tr_b16 v[80:81], v22 offset:256
    ds_read_b64_tr_b16 v[82:83], v22 offset:1792
    v_mfma_f32_32x32x16_bf16 v[160:175], v[84:87], v[100:103], v[160:175]
    v_mfma_f32_32x32x16_bf16 v[208:223], v[88:91], v[100:103], v[208:223]
    s_waitcnt lgkmcnt(0)
    v_mfma_f32_32x32x16_bf16 v[128:143], v[72:75], v[64:67], v[128:143]
    ds_read_b128 v[84:87], v17
    ds_read_b64_tr_b16 v[92:93], v22 offset:6144
    ds_read_b64_tr_b16 v[94:95], v22 offset:7680
    v_mfma_f32_32x32x16_bf16 v[176:191], v[72:75], v[68:71], v[176:191]
    ds_read_b128 v[88:91], v17 offset:4096
    ds_read_b64_tr_b16 v[96:97], v22 offset:6272
    ds_read_b64_tr_b16 v[98:99], v22 offset:7808
    v_mfma_f32_32x32x16_bf16 v[144:159], v[76:79], v[64:67], v[144:159]
    ds_read_b64_tr_b16 v[100:101], v22 offset:6400
    ds_read_b64_tr_b16 v[102:103], v22 offset:7936
    v_mfma_f32_32x32x16_bf16 v[192:207], v[76:79], v[68:71], v[192:207]
    v_mfma_f32_32x32x16_bf16 v[160:175], v[64:67], v[80:83], v[160:175]
    v_mfma_f32_32x32x16_bf16 v[208:223], v[68:71], v[80:83], v[208:223]
    s_waitcnt lgkmcnt(0)
    v_mfma_f32_32x32x16_bf16 v[128:143], v[92:95], v[84:87], v[128:143]
    ds_read_b128 v[64:67], v18
    ds_read_b64_tr_b16 v[72:73], v22 offset:12288
    ds_read_b64_tr_b16 v[74:75], v22 offset:13824
    v_mfma_f32_32x32x16_bf16 v[176:191], v[92:95], v[88:91], v[176:191]
    ds_read_b128 v[68:71], v18 offset:4096
    ds_read_b64_tr_b16 v[76:77], v22 offset:12416
    ds_read_b64_tr_b16 v[78:79], v22 offset:13952
    v_mfma_f32_32x32x16_bf16 v[144:159], v[96:99], v[84:87], v[144:159]
    ds_read_b64_tr_b16 v[80:81], v22 offset:12544
    ds_read_b64_tr_b16 v[82:83], v22 offset:14080
    v_mfma_f32_32x32x16_bf16 v[192:207], v[96:99], v[88:91], v[192:207]
    v_mfma_f32_32x32x16_bf16 v[160:175], v[84:87], v[100:103], v[160:175]
    v_mfma_f32_32x32x16_bf16 v[208:223], v[88:91], v[100:103], v[208:223]
    s_waitcnt lgkmcnt(0)
    v_mfma_f32_32x32x16_bf16 v[128:143], v[72:75], v[64:67], v[128:143]
    ds_read_b128 v[84:87], v19
    ds_read_b64_tr_b16 v[92:93], v22 offset:18432
    ds_read_b64_tr_b16 v[94:95], v22 offset:19968
    v_mfma_f32_32x32x16_bf16 v[176:191], v[72:75], v[68:71], v[176:191]
    ds_read_b128 v[88:91], v19 offset:4096
    ds_read_b64_tr_b16 v[96:97], v22 offset:18560
    ds_read_b64_tr_b16 v[98:99], v22 offset:20096
    v_mfma_f32_32x32x16_bf16 v[144:159], v[76:79], v[64:67], v[144:159]
    ds_read_b64_tr_b16 v[100:101], v22 offset:18688
    ds_read_b64_tr_b16 v[102:103], v22 offset:20224
    v_mfma_f32_32x32x16_bf16 v[192:207], v[76:79], v[68:71], v[192:207]
    v_mfma_f32_32x32x16_bf16 v[160:175], v[64:67], v[80:83], v[160:175]
    v_mfma_f32_32x32x16_bf16 v[208:223], v[68:71], v[80:83], v[208:223]
    s_waitcnt lgkmcnt(0)
    v_mfma_f32_32x32x16_bf16 v[128:143], v[92:95], v[84:87], v[128:143]
    v_mfma_f32_32x32x16_bf16 v[176:191], v[92:95], v[88:91], v[176:191]
    s_barrier
    ds_read_b128 v[64:67], v8
    ds_read_b64_tr_b16 v[72:73], v20 offset:0
    ds_read_b64_tr_b16 v[74:75], v20 offset:1536
    v_mfma_f32_32x32x16_bf16 v[144:159], v[96:99], v[84:87], v[144:159]
    ds_read_b128 v[68:71], v8 offset:4096
    ds_read_b64_tr_b16 v[76:77], v20 offset:128
    ds_read_b64_tr_b16 v[78:79], v20 offset:1664
    v_mfma_f32_32x32x16_bf16 v[192:207], v[96:99], v[88:91], v[192:207]
    ds_read_b64_tr_b16 v[80:81], v20 offset:256
    ds_read_b64_tr_b16 v[82:83], v20 offset:1792
    v_mfma_f32_32x32x16_bf16 v[160:175], v[84:87], v[100:103], v[160:175]
    v_mfma_f32_32x32x16_bf16 v[208:223], v[88:91], v[100:103], v[208:223]
    s_waitcnt lgkmcnt(0)
    v_mfma_f32_32x32x16_bf16 v[128:143], v[72:75], v[64:67], v[128:143]
    ds_read_b128 v[84:87], v9
    ds_read_b64_tr_b16 v[92:93], v20 offset:6144
    ds_read_b64_tr_b16 v[94:95], v20 offset:7680
    v_mfma_f32_32x32x16_bf16 v[176:191], v[72:75], v[68:71], v[176:191]
    ds_read_b128 v[88:91], v9 offset:4096
    ds_read_b64_tr_b16 v[96:97], v20 offset:6272
    ds_read_b64_tr_b16 v[98:99], v20 offset:7808
    v_mfma_f32_32x32x16_bf16 v[144:159], v[76:79], v[64:67], v[144:159]
    ds_read_b64_tr_b16 v[100:101], v20 offset:6400
    ds_read_b64_tr_b16 v[102:103], v20 offset:7936
    v_mfma_f32_32x32x16_bf16 v[192:207], v[76:79], v[68:71], v[192:207]
    v_mfma_f32_32x32x16_bf16 v[160:175], v[64:67], v[80:83], v[160:175]
    v_mfma_f32_32x32x16_bf16 v[208:223], v[68:71], v[80:83], v[208:223]
    s_waitcnt lgkmcnt(0)
    v_mfma_f32_32x32x16_bf16 v[128:143], v[92:95], v[84:87], v[128:143]
    ds_read_b128 v[64:67], v10
    ds_read_b64_tr_b16 v[72:73], v20 offset:12288
    ds_read_b64_tr_b16 v[74:75], v20 offset:13824
    v_mfma_f32_32x32x16_bf16 v[176:191], v[92:95], v[88:91], v[176:191]
    ds_read_b128 v[68:71], v10 offset:4096
    ds_read_b64_tr_b16 v[76:77], v20 offset:12416
    ds_read_b64_tr_b16 v[78:79], v20 offset:13952
    v_mfma_f32_32x32x16_bf16 v[144:159], v[96:99], v[84:87], v[144:159]
    ds_read_b64_tr_b16 v[80:81], v20 offset:12544
    ds_read_b64_tr_b16 v[82:83], v20 offset:14080
    v_mfma_f32_32x32x16_bf16 v[192:207], v[96:99], v[88:91], v[192:207]
    v_mfma_f32_32x32x16_bf16 v[160:175], v[84:87], v[100:103], v[160:175]
    v_mfma_f32_32x32x16_bf16 v[208:223], v[88:91], v[100:103], v[208:223]
    s_waitcnt lgkmcnt(0)
    v_mfma_f32_32x32x16_bf16 v[128:143], v[72:75], v[64:67], v[128:143]
    ds_read_b128 v[84:87], v11
    ds_read_b64_tr_b16 v[92:93], v20 offset:18432
    ds_read_b64_tr_b16 v[94:95], v20 offset:19968
    v_mfma_f32_32x32x16_bf16 v[176:191], v[72:75], v[68:71], v[176:191]
    ds_read_b128 v[88:91], v11 offset:4096
    ds_read_b64_tr_b16 v[96:97], v20 offset:18560
    ds_read_b64_tr_b16 v[98:99], v20 offset:20096
    v_mfma_f32_32x32x16_bf16 v[144:159], v[76:79], v[64:67], v[144:159]
    ds_read_b64_tr_b16 v[100:101], v20 offset:18688
    ds_read_b64_tr_b16 v[102:103], v20 offset:20224
    v_mfma_f32_32x32x16_bf16 v[192:207], v[76:79], v[68:71], v[192:207]
    v_mfma_f32_32x32x16_bf16 v[160:175], v[64:67], v[80:83], v[160:175]
    v_mfma_f32_32x32x16_bf16 v[208:223], v[68:71], v[80:83], v[208:223]
    s_waitcnt lgkmcnt(0)
    v_mfma_f32_32x32x16_bf16 v[128:143], v[92:95], v[84:87], v[128:143]
    v_mfma_f32_32x32x16_bf16 v[176:191], v[92:95], v[88:91], v[176:191]
    s_barrier
    ds_read_b128 v[64:67], v12
    ds_read_b64_tr_b16 v[72:73], v21 offset:0
    ds_read_b64_tr_b16 v[74:75], v21 offset:1536
    v_mfma_f32_32x32x16_bf16 v[144:159], v[96:99], v[84:87], v[144:159]
    ds_read_b128 v[68:71], v12 offset:4096
    ds_read_b64_tr_b16 v[76:77], v21 offset:128
    ds_read_b64_tr_b16 v[78:79], v21 offset:1664
    v_mfma_f32_32x32x16_bf16 v[192:207], v[96:99], v[88:91], v[192:207]
    ds_read_b64_tr_b16 v[80:81], v21 offset:256
    ds_read_b64_tr_b16 v[82:83], v21 offset:1792
    v_mfma_f32_32x32x16_bf16 v[160:175], v[84:87], v[100:103], v[160:175]
    v_mfma_f32_32x32x16_bf16 v[208:223], v[88:91], v[100:103], v[208:223]
    s_waitcnt lgkmcnt(0)
    v_mfma_f32_32x32x16_bf16 v[128:143], v[72:75], v[64:67], v[128:143]
    ds_read_b128 v[84:87], v13
    ds_read_b64_tr_b16 v[92:93], v21 offset:6144
    ds_read_b64_tr_b16 v[94:95], v21 offset:7680
    v_mfma_f32_32x32x16_bf16 v[176:191], v[72:75], v[68:71], v[176:191]
    ds_read_b128 v[88:91], v13 offset:4096
    ds_read_b64_tr_b16 v[96:97], v21 offset:6272
    ds_read_b64_tr_b16 v[98:99], v21 offset:7808
    v_mfma_f32_32x32x16_bf16 v[144:159], v[76:79], v[64:67], v[144:159]
    ds_read_b64_tr_b16 v[100:101], v21 offset:6400
    ds_read_b64_tr_b16 v[102:103], v21 offset:7936
    v_mfma_f32_32x32x16_bf16 v[192:207], v[76:79], v[68:71], v[192:207]
    v_mfma_f32_32x32x16_bf16 v[160:175], v[64:67], v[80:83], v[160:175]
    v_mfma_f32_32x32x16_bf16 v[208:223], v[68:71], v[80:83], v[208:223]
    s_waitcnt lgkmcnt(0)
    v_mfma_f32_32x32x16_bf16 v[128:143], v[92:95], v[84:87], v[128:143]
    ds_read_b128 v[64:67], v14
    ds_read_b64_tr_b16 v[72:73], v21 offset:12288
    ds_read_b64_tr_b16 v[74:75], v21 offset:13824
    v_mfma_f32_32x32x16_bf16 v[176:191], v[92:95], v[88:91], v[176:191]
    ds_read_b128 v[68:71], v14 offset:4096
    ds_read_b64_tr_b16 v[76:77], v21 offset:12416
    ds_read_b64_tr_b16 v[78:79], v21 offset:13952
    v_mfma_f32_32x32x16_bf16 v[144:159], v[96:99], v[84:87], v[144:159]
    ds_read_b64_tr_b16 v[80:81], v21 offset:12544
    ds_read_b64_tr_b16 v[82:83], v21 offset:14080
    v_mfma_f32_32x32x16_bf16 v[192:207], v[96:99], v[88:91], v[192:207]
    v_mfma_f32_32x32x16_bf16 v[160:175], v[84:87], v[100:103], v[160:175]
    v_mfma_f32_32x32x16_bf16 v[208:223], v[88:91], v[100:103], v[208:223]
    s_waitcnt lgkmcnt(0)
    v_mfma_f32_32x32x16_bf16 v[128:143], v[72:75], v[64:67], v[128:143]
    ds_read_b128 v[84:87], v15
    ds_read_b64_tr_b16 v[92:93], v21 offset:18432
    ds_read_b64_tr_b16 v[94:95], v21 offset:19968
    v_mfma_f32_32x32x16_bf16 v[176:191], v[72:75], v[68:71], v[176:191]
    ds_read_b128 v[88:91], v15 offset:4096
    ds_read_b64_tr_b16 v[96:97], v21 offset:18560
    ds_read_b64_tr_b16 v[98:99], v21 offset:20096
    v_mfma_f32_32x32x16_bf16 v[144:159], v[76:79], v[64:67], v[144:159]
    ds_read_b64_tr_b16 v[100:101], v21 offset:18688
    ds_read_b64_tr_b16 v[102:103], v21 offset:20224
    v_mfma_f32_32x32x16_bf16 v[192:207], v[76:79], v[68:71], v[192:207]
    v_mfma_f32_32x32x16_bf16 v[160:175], v[64:67], v[80:83], v[160:175]
    v_mfma_f32_32x32x16_bf16 v[208:223], v[68:71], v[80:83], v[208:223]
    s_waitcnt lgkmcnt(0)
    v_mfma_f32_32x32x16_bf16 v[128:143], v[92:95], v[84:87], v[128:143]
    v_mfma_f32_32x32x16_bf16 v[176:191], v[92:95], v[88:91], v[176:191]
    s_barrier
    ds_read_b128 v[64:67], v16
    ds_read_b64_tr_b16 v[72:73], v22 offset:0
    ds_read_b64_tr_b16 v[74:75], v22 offset:1536
    v_mfma_f32_32x32x16_bf16 v[144:159], v[96:99], v[84:87], v[144:159]
    ds_read_b128 v[68:71], v16 offset:4096
    ds_read_b64_tr_b16 v[76:77], v22 offset:128
    ds_read_b64_tr_b16 v[78:79], v22 offset:1664
    v_mfma_f32_32x32x16_bf16 v[192:207], v[96:99], v[88:91], v[192:207]
    ds_read_b64_tr_b16 v[80:81], v22 offset:256
    ds_read_b64_tr_b16 v[82:83], v22 offset:1792
    v_mfma_f32_32x32x16_bf16 v[160:175], v[84:87], v[100:103], v[160:175]
    v_mfma_f32_32x32x16_bf16 v[208:223], v[88:91], v[100:103], v[208:223]
    s_waitcnt lgkmcnt(0)
    v_mfma_f32_32x32x16_bf16 v[128:143], v[72:75], v[64:67], v[128:143]
    ds_read_b128 v[84:87], v17
    ds_read_b64_tr_b16 v[92:93], v22 offset:6144
    ds_read_b64_tr_b16 v[94:95], v22 offset:7680
    v_mfma_f32_32x32x16_bf16 v[176:191], v[72:75], v[68:71], v[176:191]
    ds_read_b128 v[88:91], v17 offset:4096
    ds_read_b64_tr_b16 v[96:97], v22 offset:6272
    ds_read_b64_tr_b16 v[98:99], v22 offset:7808
    v_mfma_f32_32x32x16_bf16 v[144:159], v[76:79], v[64:67], v[144:159]
    ds_read_b64_tr_b16 v[100:101], v22 offset:6400
    ds_read_b64_tr_b16 v[102:103], v22 offset:7936
    v_mfma_f32_32x32x16_bf16 v[192:207], v[76:79], v[68:71], v[192:207]
    v_mfma_f32_32x32x16_bf16 v[160:175], v[64:67], v[80:83], v[160:175]
    v_mfma_f32_32x32x16_bf16 v[208:223], v[68:71], v[80:83], v[208:223]
    s_waitcnt lgkmcnt(0)
    v_mfma_f32_32x32x16_bf16 v[128:143], v[92:95], v[84:87], v[128:143]
    ds_read_b128 v[64:67], v18
    ds_read_b64_tr_b16 v[72:73], v22 offset:12288
    ds_read_b64_tr_b16 v[74:75], v22 offset:13824
    v_mfma_f32_32x32x16_bf16 v[176:191], v[92:95], v[88:91], v[176:191]
    ds_read_b128 v[68:71], v18 offset:4096
    ds_read_b64_tr_b16 v[76:77], v22 offset:12416
    ds_read_b64_tr_b16 v[78:79], v22 offset:13952
    v_mfma_f32_32x32x16_bf16 v[144:159], v[96:99], v[84:87], v[144:159]
    ds_read_b64_tr_b16 v[80:81], v22 offset:12544
    ds_read_b64_tr_b16 v[82:83], v22 offset:14080
    v_mfma_f32_32x32x16_bf16 v[192:207], v[96:99], v[88:91], v[192:207]
    v_mfma_f32_32x32x16_bf16 v[160:175], v[84:87], v[100:103], v[160:175]
    v_mfma_f32_32x32x16_bf16 v[208:223], v[88:91], v[100:103], v[208:223]
    s_waitcnt lgkmcnt(0)
    v_mfma_f32_32x32x16_bf16 v[128:143], v[72:75], v[64:67], v[128:143]
    ds_read_b128 v[84:87], v19
    ds_read_b64_tr_b16 v[92:93], v22 offset:18432
    ds_read_b64_tr_b16 v[94:95], v22 offset:19968
    v_mfma_f32_32x32x16_bf16 v[176:191], v[72:75], v[68:71], v[176:191]
    ds_read_b128 v[88:91], v19 offset:4096
    ds_read_b64_tr_b16 v[96:97], v22 offset:18560
    ds_read_b64_tr_b16 v[98:99], v22 offset:20096
    v_mfma_f32_32x32x16_bf16 v[144:159], v[76:79], v[64:67], v[144:159]
    ds_read_b64_tr_b16 v[100:101], v22 offset:18688
    ds_read_b64_tr_b16 v[102:103], v22 offset:20224
    v_mfma_f32_32x32x16_bf16 v[192:207], v[76:79], v[68:71], v[192:207]
    v_mfma_f32_32x32x16_bf16 v[160:175], v[64:67], v[80:83], v[160:175]
    v_mfma_f32_32x32x16_bf16 v[208:223], v[68:71], v[80:83], v[208:223]
    s_waitcnt lgkmcnt(0)
    v_mfma_f32_32x32x16_bf16 v[128:143], v[92:95], v[84:87], v[128:143]
    v_mfma_f32_32x32x16_bf16 v[176:191], v[92:95], v[88:91], v[176:191]
    s_barrier
    ds_read_b128 v[64:67], v8
    ds_read_b64_tr_b16 v[72:73], v20 offset:0
    ds_read_b64_tr_b16 v[74:75], v20 offset:1536
    v_mfma_f32_32x32x16_bf16 v[144:159], v[96:99], v[84:87], v[144:159]
    ds_read_b128 v[68:71], v8 offset:4096
    ds_read_b64_tr_b16 v[76:77], v20 offset:128
    ds_read_b64_tr_b16 v[78:79], v20 offset:1664
    v_mfma_f32_32x32x16_bf16 v[192:207], v[96:99], v[88:91], v[192:207]
    ds_read_b64_tr_b16 v[80:81], v20 offset:256
    ds_read_b64_tr_b16 v[82:83], v20 offset:1792
    v_mfma_f32_32x32x16_bf16 v[160:175], v[84:87], v[100:103], v[160:175]
    v_mfma_f32_32x32x16_bf16 v[208:223], v[88:91], v[100:103], v[208:223]
    s_waitcnt lgkmcnt(0)
    v_mfma_f32_32x32x16_bf16 v[128:143], v[72:75], v[64:67], v[128:143]
    ds_read_b128 v[84:87], v9
    ds_read_b64_tr_b16 v[92:93], v20 offset:6144
    ds_read_b64_tr_b16 v[94:95], v20 offset:7680
    v_mfma_f32_32x32x16_bf16 v[176:191], v[72:75], v[68:71], v[176:191]
    ds_read_b128 v[88:91], v9 offset:4096
    ds_read_b64_tr_b16 v[96:97], v20 offset:6272
    ds_read_b64_tr_b16 v[98:99], v20 offset:7808
    v_mfma_f32_32x32x16_bf16 v[144:159], v[76:79], v[64:67], v[144:159]
    ds_read_b64_tr_b16 v[100:101], v20 offset:6400
    ds_read_b64_tr_b16 v[102:103], v20 offset:7936
    v_mfma_f32_32x32x16_bf16 v[192:207], v[76:79], v[68:71], v[192:207]
    v_mfma_f32_32x32x16_bf16 v[160:175], v[64:67], v[80:83], v[160:175]
    v_mfma_f32_32x32x16_bf16 v[208:223], v[68:71], v[80:83], v[208:223]
    s_waitcnt lgkmcnt(0)
    v_mfma_f32_32x32x16_bf16 v[128:143], v[92:95], v[84:87], v[128:143]
    ds_read_b128 v[64:67], v10
    ds_read_b64_tr_b16 v[72:73], v20 offset:12288
    ds_read_b64_tr_b16 v[74:75], v20 offset:13824
    v_mfma_f32_32x32x16_bf16 v[176:191], v[92:95], v[88:91], v[176:191]
    ds_read_b128 v[68:71], v10 offset:4096
    ds_read_b64_tr_b16 v[76:77], v20 offset:12416
    ds_read_b64_tr_b16 v[78:79], v20 offset:13952
    v_mfma_f32_32x32x16_bf16 v[144:159], v[96:99], v[84:87], v[144:159]
    ds_read_b64_tr_b16 v[80:81], v20 offset:12544
    ds_read_b64_tr_b16 v[82:83], v20 offset:14080
    v_mfma_f32_32x32x16_bf16 v[192:207], v[96:99], v[88:91], v[192:207]
    v_mfma_f32_32x32x16_bf16 v[160:175], v[84:87], v[100:103], v[160:175]
    v_mfma_f32_32x32x16_bf16 v[208:223], v[88:91], v[100:103], v[208:223]
    s_waitcnt lgkmcnt(0)
    v_mfma_f32_32x32x16_bf16 v[128:143], v[72:75], v[64:67], v[128:143]
    ds_read_b128 v[84:87], v11
    ds_read_b64_tr_b16 v[92:93], v20 offset:18432
    ds_read_b64_tr_b16 v[94:95], v20 offset:19968
    v_mfma_f32_32x32x16_bf16 v[176:191], v[72:75], v[68:71], v[176:191]
    ds_read_b128 v[88:91], v11 offset:4096
    ds_read_b64_tr_b16 v[96:97], v20 offset:18560
    ds_read_b64_tr_b16 v[98:99], v20 offset:20096
    v_mfma_f32_32x32x16_bf16 v[144:159], v[76:79], v[64:67], v[144:159]
    ds_read_b64_tr_b16 v[100:101], v20 offset:18688
    ds_read_b64_tr_b16 v[102:103], v20 offset:20224
    v_mfma_f32_32x32x16_bf16 v[192:207], v[76:79], v[68:71], v[192:207]
    v_mfma_f32_32x32x16_bf16 v[160:175], v[64:67], v[80:83], v[160:175]
    v_mfma_f32_32x32x16_bf16 v[208:223], v[68:71], v[80:83], v[208:223]
    s_waitcnt lgkmcnt(0)
    v_mfma_f32_32x32x16_bf16 v[128:143], v[92:95], v[84:87], v[128:143]
    v_mfma_f32_32x32x16_bf16 v[176:191], v[92:95], v[88:91], v[176:191]
    s_barrier
    ds_read_b128 v[64:67], v12
    ds_read_b64_tr_b16 v[72:73], v21 offset:0
    ds_read_b64_tr_b16 v[74:75], v21 offset:1536
    v_mfma_f32_32x32x16_bf16 v[144:159], v[96:99], v[84:87], v[144:159]
    ds_read_b128 v[68:71], v12 offset:4096
    ds_read_b64_tr_b16 v[76:77], v21 offset:128
    ds_read_b64_tr_b16 v[78:79], v21 offset:1664
    v_mfma_f32_32x32x16_bf16 v[192:207], v[96:99], v[88:91], v[192:207]
    ds_read_b64_tr_b16 v[80:81], v21 offset:256
    ds_read_b64_tr_b16 v[82:83], v21 offset:1792
    v_mfma_f32_32x32x16_bf16 v[160:175], v[84:87], v[100:103], v[160:175]
    v_mfma_f32_32x32x16_bf16 v[208:223], v[88:91], v[100:103], v[208:223]
    s_waitcnt lgkmcnt(0)
    v_mfma_f32_32x32x16_bf16 v[128:143], v[72:75], v[64:67], v[128:143]
    ds_read_b128 v[84:87], v13
    ds_read_b64_tr_b16 v[92:93], v21 offset:6144
    ds_read_b64_tr_b16 v[94:95], v21 offset:7680
    v_mfma_f32_32x32x16_bf16 v[176:191], v[72:75], v[68:71], v[176:191]
    ds_read_b128 v[88:91], v13 offset:4096
    ds_read_b64_tr_b16 v[96:97], v21 offset:6272
    ds_read_b64_tr_b16 v[98:99], v21 offset:7808
    v_mfma_f32_32x32x16_bf16 v[144:159], v[76:79], v[64:67], v[144:159]
    ds_read_b64_tr_b16 v[100:101], v21 offset:6400
    ds_read_b64_tr_b16 v[102:103], v21 offset:7936
    v_mfma_f32_32x32x16_bf16 v[192:207], v[76:79], v[68:71], v[192:207]
    v_mfma_f32_32x32x16_bf16 v[160:175], v[64:67], v[80:83], v[160:175]
    v_mfma_f32_32x32x16_bf16 v[208:223], v[68:71], v[80:83], v[208:223]
    s_waitcnt lgkmcnt(0)
    v_mfma_f32_32x32x16_bf16 v[128:143], v[92:95], v[84:87], v[128:143]
    ds_read_b128 v[64:67], v14
    ds_read_b64_tr_b16 v[72:73], v21 offset:12288
    ds_read_b64_tr_b16 v[74:75], v21 offset:13824
    v_mfma_f32_32x32x16_bf16 v[176:191], v[92:95], v[88:91], v[176:191]
    ds_read_b128 v[68:71], v14 offset:4096
    ds_read_b64_tr_b16 v[76:77], v21 offset:12416
    ds_read_b64_tr_b16 v[78:79], v21 offset:13952
    v_mfma_f32_32x32x16_bf16 v[144:159], v[96:99], v[84:87], v[144:159]
    ds_read_b64_tr_b16 v[80:81], v21 offset:12544
    ds_read_b64_tr_b16 v[82:83], v21 offset:14080
    v_mfma_f32_32x32x16_bf16 v[192:207], v[96:99], v[88:91], v[192:207]
    v_mfma_f32_32x32x16_bf16 v[160:175], v[84:87], v[100:103], v[160:175]
    v_mfma_f32_32x32x16_bf16 v[208:223], v[88:91], v[100:103], v[208:223]
    s_waitcnt lgkmcnt(0)
    v_mfma_f32_32x32x16_bf16 v[128:143], v[72:75], v[64:67], v[128:143]
    ds_read_b128 v[84:87], v15
    ds_read_b64_tr_b16 v[92:93], v21 offset:18432
    ds_read_b64_tr_b16 v[94:95], v21 offset:19968
    v_mfma_f32_32x32x16_bf16 v[176:191], v[72:75], v[68:71], v[176:191]
    ds_read_b128 v[88:91], v15 offset:4096
    ds_read_b64_tr_b16 v[96:97], v21 offset:18560
    ds_read_b64_tr_b16 v[98:99], v21 offset:20096
    v_mfma_f32_32x32x16_bf16 v[144:159], v[76:79], v[64:67], v[144:159]
    ds_read_b64_tr_b16 v[100:101], v21 offset:18688
    ds_read_b64_tr_b16 v[102:103], v21 offset:20224
    v_mfma_f32_32x32x16_bf16 v[192:207], v[76:79], v[68:71], v[192:207]
    v_mfma_f32_32x32x16_bf16 v[160:175], v[64:67], v[80:83], v[160:175]
    v_mfma_f32_32x32x16_bf16 v[208:223], v[68:71], v[80:83], v[208:223]
    s_waitcnt lgkmcnt(0)
    v_mfma_f32_32x32x16_bf16 v[128:143], v[92:95], v[84:87], v[128:143]
    v_mfma_f32_32x32x16_bf16 v[176:191], v[92:95], v[88:91], v[176:191]
    s_barrier
    ds_read_b128 v[64:67], v16
    ds_read_b64_tr_b16 v[72:73], v22 offset:0
    ds_read_b64_tr_b16 v[74:75], v22 offset:1536
    v_mfma_f32_32x32x16_bf16 v[144:159], v[96:99], v[84:87], v[144:159]
    ds_read_b128 v[68:71], v16 offset:4096
    ds_read_b64_tr_b16 v[76:77], v22 offset:128
    ds_read_b64_tr_b16 v[78:79], v22 offset:1664
    v_mfma_f32_32x32x16_bf16 v[192:207], v[96:99], v[88:91], v[192:207]
    ds_read_b64_tr_b16 v[80:81], v22 offset:256
    ds_read_b64_tr_b16 v[82:83], v22 offset:1792
    v_mfma_f32_32x32x16_bf16 v[160:175], v[84:87], v[100:103], v[160:175]
    v_mfma_f32_32x32x16_bf16 v[208:223], v[88:91], v[100:103], v[208:223]
    s_waitcnt lgkmcnt(0)
    v_mfma_f32_32x32x16_bf16 v[128:143], v[72:75], v[64:67], v[128:143]
    ds_read_b128 v[84:87], v17
    ds_read_b64_tr_b16 v[92:93], v22 offset:6144
    ds_read_b64_tr_b16 v[94:95], v22 offset:7680
    v_mfma_f32_32x32x16_bf16 v[176:191], v[72:75], v[68:71], v[176:191]
    ds_read_b128 v[88:91], v17 offset:4096
    ds_read_b64_tr_b16 v[96:97], v22 offset:6272
    ds_read_b64_tr_b16 v[98:99], v22 offset:7808
    v_mfma_f32_32x32x16_bf16 v[144:159], v[76:79], v[64:67], v[144:159]
    ds_read_b64_tr_b16 v[100:101], v22 offset:6400
    ds_read_b64_tr_b16 v[102:103], v22 offset:7936
    v_mfma_f32_32x32x16_bf16 v[192:207], v[76:79], v[68:71], v[192:207]
    v_mfma_f32_32x32x16_bf16 v[160:175], v[64:67], v[80:83], v[160:175]
    v_mfma_f32_32x32x16_bf16 v[208:223], v[68:71], v[80:83], v[208:223]
    s_waitcnt lgkmcnt(0)
    v_mfma_f32_32x32x16_bf16 v[128:143], v[92:95], v[84:87], v[128:143]
    ds_read_b128 v[64:67], v18
    ds_read_b64_tr_b16 v[72:73], v22 offset:12288
    ds_read_b64_tr_b16 v[74:75], v22 offset:13824
    v_mfma_f32_32x32x16_bf16 v[176:191], v[92:95], v[88:91], v[176:191]
    ds_read_b128 v[68:71], v18 offset:4096
    ds_read_b64_tr_b16 v[76:77], v22 offset:12416
    ds_read_b64_tr_b16 v[78:79], v22 offset:13952
    v_mfma_f32_32x32x16_bf16 v[144:159], v[96:99], v[84:87], v[144:159]
    ds_read_b64_tr_b16 v[80:81], v22 offset:12544
    ds_read_b64_tr_b16 v[82:83], v22 offset:14080
    v_mfma_f32_32x32x16_bf16 v[192:207], v[96:99], v[88:91], v[192:207]
    v_mfma_f32_32x32x16_bf16 v[160:175], v[84:87], v[100:103], v[160:175]
    v_mfma_f32_32x32x16_bf16 v[208:223], v[88:91], v[100:103], v[208:223]
    s_waitcnt lgkmcnt(0)
    v_mfma_f32_32x32x16_bf16 v[128:143], v[72:75], v[64:67], v[128:143]
    ds_read_b128 v[84:87], v19
    ds_read_b64_tr_b16 v[92:93], v22 offset:18432
    ds_read_b64_tr_b16 v[94:95], v22 offset:19968
    v_mfma_f32_32x32x16_bf16 v[176:191], v[72:75], v[68:71], v[176:191]
    ds_read_b128 v[88:91], v19 offset:4096
    ds_read_b64_tr_b16 v[96:97], v22 offset:18560
    ds_read_b64_tr_b16 v[98:99], v22 offset:20096
    v_mfma_f32_32x32x16_bf16 v[144:159], v[76:79], v[64:67], v[144:159]
    ds_read_b64_tr_b16 v[100:101], v22 offset:18688
    ds_read_b64_tr_b16 v[102:103], v22 offset:20224
    v_mfma_f32_32x32x16_bf16 v[192:207], v[76:79], v[68:71], v[192:207]
    v_mfma_f32_32x32x16_bf16 v[160:175], v[64:67], v[80:83], v[160:175]
    v_mfma_f32_32x32x16_bf16 v[208:223], v[68:71], v[80:83], v[208:223]
    s_waitcnt lgkmcnt(0)
    v_mfma_f32_32x32x16_bf16 v[128:143], v[92:95], v[84:87], v[128:143]
    v_mfma_f32_32x32x16_bf16 v[176:191], v[92:95], v[88:91], v[176:191]
    s_barrier
    ds_read_b128 v[64:67], v8
    ds_read_b64_tr_b16 v[72:73], v20 offset:0
    ds_read_b64_tr_b16 v[74:75], v20 offset:1536
    v_mfma_f32_32x32x16_bf16 v[144:159], v[96:99], v[84:87], v[144:159]
    ds_read_b128 v[68:71], v8 offset:4096
    ds_read_b64_tr_b16 v[76:77], v20 offset:128
    ds_read_b64_tr_b16 v[78:79], v20 offset:1664
    v_mfma_f32_32x32x16_bf16 v[192:207], v[96:99], v[88:91], v[192:207]
    ds_read_b64_tr_b16 v[80:81], v20 offset:256
    ds_read_b64_tr_b16 v[82:83], v20 offset:1792
    v_mfma_f32_32x32x16_bf16 v[160:175], v[84:87], v[100:103], v[160:175]
    v_mfma_f32_32x32x16_bf16 v[208:223], v[88:91], v[100:103], v[208:223]
    s_waitcnt lgkmcnt(0)
    v_mfma_f32_32x32x16_bf16 v[128:143], v[72:75], v[64:67], v[128:143]
    ds_read_b128 v[84:87], v9
    ds_read_b64_tr_b16 v[92:93], v20 offset:6144
    ds_read_b64_tr_b16 v[94:95], v20 offset:7680
    v_mfma_f32_32x32x16_bf16 v[176:191], v[72:75], v[68:71], v[176:191]
    ds_read_b128 v[88:91], v9 offset:4096
    ds_read_b64_tr_b16 v[96:97], v20 offset:6272
    ds_read_b64_tr_b16 v[98:99], v20 offset:7808
    v_mfma_f32_32x32x16_bf16 v[144:159], v[76:79], v[64:67], v[144:159]
    ds_read_b64_tr_b16 v[100:101], v20 offset:6400
    ds_read_b64_tr_b16 v[102:103], v20 offset:7936
    v_mfma_f32_32x32x16_bf16 v[192:207], v[76:79], v[68:71], v[192:207]
    v_mfma_f32_32x32x16_bf16 v[160:175], v[64:67], v[80:83], v[160:175]
    v_mfma_f32_32x32x16_bf16 v[208:223], v[68:71], v[80:83], v[208:223]
    s_waitcnt lgkmcnt(0)
    v_mfma_f32_32x32x16_bf16 v[128:143], v[92:95], v[84:87], v[128:143]
    ds_read_b128 v[64:67], v10
    ds_read_b64_tr_b16 v[72:73], v20 offset:12288
    ds_read_b64_tr_b16 v[74:75], v20 offset:13824
    v_mfma_f32_32x32x16_bf16 v[176:191], v[92:95], v[88:91], v[176:191]
    ds_read_b128 v[68:71], v10 offset:4096
    ds_read_b64_tr_b16 v[76:77], v20 offset:12416
    ds_read_b64_tr_b16 v[78:79], v20 offset:13952
    v_mfma_f32_32x32x16_bf16 v[144:159], v[96:99], v[84:87], v[144:159]
    ds_read_b64_tr_b16 v[80:81], v20 offset:12544
    ds_read_b64_tr_b16 v[82:83], v20 offset:14080
    v_mfma_f32_32x32x16_bf16 v[192:207], v[96:99], v[88:91], v[192:207]
    v_mfma_f32_32x32x16_bf16 v[160:175], v[84:87], v[100:103], v[160:175]
    v_mfma_f32_32x32x16_bf16 v[208:223], v[88:91], v[100:103], v[208:223]
    s_waitcnt lgkmcnt(0)
    v_mfma_f32_32x32x16_bf16 v[128:143], v[72:75], v[64:67], v[128:143]
    ds_read_b128 v[84:87], v11
    ds_read_b64_tr_b16 v[92:93], v20 offset:18432
    ds_read_b64_tr_b16 v[94:95], v20 offset:19968
    v_mfma_f32_32x32x16_bf16 v[176:191], v[72:75], v[68:71], v[176:191]
    ds_read_b128 v[88:91], v11 offset:4096
    ds_read_b64_tr_b16 v[96:97], v20 offset:18560
    ds_read_b64_tr_b16 v[98:99], v20 offset:20096
    v_mfma_f32_32x32x16_bf16 v[144:159], v[76:79], v[64:67], v[144:159]
    ds_read_b64_tr_b16 v[100:101], v20 offset:18688
    ds_read_b64_tr_b16 v[102:103], v20 offset:20224
    v_mfma_f32_32x32x16_bf16 v[192:207], v[76:79], v[68:71], v[192:207]
    v_mfma_f32_32x32x16_bf16 v[160:175], v[64:67], v[80:83], v[160:175]
    v_mfma_f32_32x32x16_bf16 v[208:223], v[68:71], v[80:83], v[208:223]
    s_waitcnt lgkmcnt(0)
    v_mfma_f32_32x32x16_bf16 v[128:143], v[92:95], v[84:87], v[128:143]
    v_mfma_f32_32x32x16_bf16 v[176:191], v[92:95], v[88:91], v[176:191]
    v_mfma_f32_32x32x16_bf16 v[144:159], v[96:99], v[84:87], v[144:159]
    v_mfma_f32_32x32x16_bf16 v[192:207], v[96:99], v[88:91], v[192:207]
    v_mfma_f32_32x32x16_bf16 v[160:175], v[84:87], v[100:103], v[160:175]
    v_mfma_f32_32x32x16_bf16 v[208:223], v[88:91], v[100:103], v[208:223]
    s_setprio 0
    s_barrier
    s_nop 7
    s_nop 7
    v_and_b32 v2, 31, v1
    v_lshrrev_b32 v3, 5, v1
    s_and_b32 s48, s29, 1
    s_lshr_b32 s49, s29, 1
    s_lshl_b32 s30, s48, 8
    v_lshl_add_u32 v4, v2, 2, s30
    s_lshl_b32 s31, s49, 7
    v_lshl_add_u32 v5, v3, 4, s31
    v_lshl_add_u32 v6, v2, 2, s31
    v_lshl_add_u32 v7, v3, 4, s30
    v_add_u32 v4, 155648, v4
    v_add_u32 v5, 155648, v5
    v_add_u32 v6, 155648, v6
    v_add_u32 v7, 155648, v7
    ds_read_b32 v58, v4 offset:0
    ds_read_b32 v59, v4 offset:512
    ds_read_b32 v60, v4 offset:128
    ds_read_b32 v61, v4 offset:640
    ds_read_b32 v56, v6 offset:1536
    ds_read_b128 v[24:27], v5 offset:1024
    ds_read_b128 v[40:43], v5 offset:1280
    ds_read_b128 v[28:31], v5 offset:1056
    ds_read_b128 v[44:47], v5 offset:1312
    ds_read_b128 v[32:35], v5 offset:1088
    ds_read_b128 v[48:51], v5 offset:1344
    ds_read_b128 v[36:39], v5 offset:1120
    ds_read_b128 v[52:55], v5 offset:1376
    v_lshlrev_b32 v8, 4, v1
    s_lshl_b32 s30, s49, 14
    s_lshl_b32 s31, s48, 12
    s_add_u32 s30, s30, s31
    v_add_u32 v9, s30, v8
    s_lshl_b32 s32, s34, 15
    s_add_u32 s50, s32, 0
    s_add_u32 s51, s50, 8192
    s_lshl_b32 s30, s49, 13
    s_add_u32 s30, s30, s31
    v_add_u32 v10, s30, v8
    v_add_u32 v10, 73728, v10
    s_cmp_eq_u32 s26, 15
    s_cselect_b32 s30, 0x7f000000, 0
    v_add_u32 v11, s30, v9
    s_waitcnt lgkmcnt(0)
    v_sub_f32 v58, 0, v58
    v_sub_f32 v60, 0, v60
    v_sub_f32 v56, 0, v56
    v_mov_b32 v62, 0
    v_mul_f32 v63, 0x3e8293ee, v59
    v_mul_f32 v65, 0x3e8293ee, v61
    ds_read_b128 v[68:71], v7 offset:0
    ds_read_b128 v[84:87], v7 offset:512
    ds_read_b128 v[72:75], v7 offset:32
    ds_read_b128 v[88:91], v7 offset:544
    ds_read_b128 v[76:79], v7 offset:64
    ds_read_b128 v[92:95], v7 offset:576
    ds_read_b128 v[80:83], v7 offset:96
    ds_read_b128 v[96:99], v7 offset:608
    v_pk_fma_f32 v[144:145], v[40:41], v[58:59], v[144:145] op_sel:[0,0,0] op_sel_hi:[1,0,1]
    v_pk_fma_f32 v[146:147], v[42:43], v[58:59], v[146:147] op_sel:[0,0,0] op_sel_hi:[1,0,1]
    v_pk_fma_f32 v[148:149], v[44:45], v[58:59], v[148:149] op_sel:[0,0,0] op_sel_hi:[1,0,1]
    v_pk_fma_f32 v[150:151], v[46:47], v[58:59], v[150:151] op_sel:[0,0,0] op_sel_hi:[1,0,1]
    v_pk_fma_f32 v[152:153], v[48:49], v[58:59], v[152:153] op_sel:[0,0,0] op_sel_hi:[1,0,1]
    v_pk_fma_f32 v[154:155], v[50:51], v[58:59], v[154:155] op_sel:[0,0,0] op_sel_hi:[1,0,1]
    v_pk_fma_f32 v[156:157], v[52:53], v[58:59], v[156:157] op_sel:[0,0,0] op_sel_hi:[1,0,1]
    v_pk_fma_f32 v[158:159], v[54:55], v[58:59], v[158:159] op_sel:[0,0,0] op_sel_hi:[1,0,1]
    v_pk_mul_f32 v[144:145], v[144:145], v[58:59] op_sel:[0,1] op_sel_hi:[1,1]
    v_pk_mul_f32 v[146:147], v[146:147], v[58:59] op_sel:[0,1] op_sel_hi:[1,1]
    v_pk_mul_f32 v[148:149], v[148:149], v[58:59] op_sel:[0,1] op_sel_hi:[1,1]
    v_pk_mul_f32 v[150:151], v[150:151], v[58:59] op_sel:[0,1] op_sel_hi:[1,1]
    v_pk_mul_f32 v[152:153], v[152:153], v[58:59] op_sel:[0,1] op_sel_hi:[1,1]
    v_pk_mul_f32 v[154:155], v[154:155], v[58:59] op_sel:[0,1] op_sel_hi:[1,1]
    v_pk_mul_f32 v[156:157], v[156:157], v[58:59] op_sel:[0,1] op_sel_hi:[1,1]
    v_pk_mul_f32 v[158:159], v[158:159], v[58:59] op_sel:[0,1] op_sel_hi:[1,1]
    v_cvt_pk_bf16_f32 v100, v144, v145
    v_cvt_pk_bf16_f32 v101, v146, v147
    v_cvt_pk_bf16_f32 v102, v148, v149
    v_cvt_pk_bf16_f32 v103, v150, v151
    v_cvt_pk_bf16_f32 v104, v152, v153
    v_cvt_pk_bf16_f32 v105, v154, v155
    v_cvt_pk_bf16_f32 v106, v156, v157
    v_cvt_pk_bf16_f32 v107, v158, v159
    ds_write_b128 v9, v[100:103] offset:40960
    buffer_store_dwordx4 v[100:103], v11, s[12:15], s50 offen offset:0 sc1
    ds_write_b128 v9, v[104:107] offset:41984
    buffer_store_dwordx4 v[104:107], v11, s[12:15], s50 offen offset:1024 sc1
    v_pk_fma_f32 v[192:193], v[40:41], v[60:61], v[192:193] op_sel:[0,0,0] op_sel_hi:[1,0,1]
    v_pk_fma_f32 v[194:195], v[42:43], v[60:61], v[194:195] op_sel:[0,0,0] op_sel_hi:[1,0,1]
    v_pk_fma_f32 v[196:197], v[44:45], v[60:61], v[196:197] op_sel:[0,0,0] op_sel_hi:[1,0,1]
    v_pk_fma_f32 v[198:199], v[46:47], v[60:61], v[198:199] op_sel:[0,0,0] op_sel_hi:[1,0,1]
    v_pk_fma_f32 v[200:201], v[48:49], v[60:61], v[200:201] op_sel:[0,0,0] op_sel_hi:[1,0,1]
    v_pk_fma_f32 v[202:203], v[50:51], v[60:61], v[202:203] op_sel:[0,0,0] op_sel_hi:[1,0,1]
    v_pk_fma_f32 v[204:205], v[52:53], v[60:61], v[204:205] op_sel:[0,0,0] op_sel_hi:[1,0,1]
    v_pk_fma_f32 v[206:207], v[54:55], v[60:61], v[206:207] op_sel:[0,0,0] op_sel_hi:[1,0,1]
    v_pk_mul_f32 v[192:193], v[192:193], v[60:61] op_sel:[0,1] op_sel_hi:[1,1]
    v_pk_mul_f32 v[194:195], v[194:195], v[60:61] op_sel:[0,1] op_sel_hi:[1,1]
    v_pk_mul_f32 v[196:197], v[196:197], v[60:61] op_sel:[0,1] op_sel_hi:[1,1]
    v_pk_mul_f32 v[198:199], v[198:199], v[60:61] op_sel:[0,1] op_sel_hi:[1,1]
    v_pk_mul_f32 v[200:201], v[200:201], v[60:61] op_sel:[0,1] op_sel_hi:[1,1]
    v_pk_mul_f32 v[202:203], v[202:203], v[60:61] op_sel:[0,1] op_sel_hi:[1,1]
    v_pk_mul_f32 v[204:205], v[204:205], v[60:61] op_sel:[0,1] op_sel_hi:[1,1]
    v_pk_mul_f32 v[206:207], v[206:207], v[60:61] op_sel:[0,1] op_sel_hi:[1,1]
    v_cvt_pk_bf16_f32 v108, v192, v193
    v_cvt_pk_bf16_f32 v109, v194, v195
    v_cvt_pk_bf16_f32 v110, v196, v197
    v_cvt_pk_bf16_f32 v111, v198, v199
    v_cvt_pk_bf16_f32 v112, v200, v201
    v_cvt_pk_bf16_f32 v113, v202, v203
    v_cvt_pk_bf16_f32 v114, v204, v205
    v_cvt_pk_bf16_f32 v115, v206, v207
    ds_write_b128 v9, v[108:111] offset:43008
    buffer_store_dwordx4 v[108:111], v11, s[12:15], s50 offen offset:2048 sc1
    ds_write_b128 v9, v[112:115] offset:44032
    buffer_store_dwordx4 v[112:115], v11, s[12:15], s50 offen offset:3072 sc1
    s_waitcnt lgkmcnt(4)
    v_pk_fma_f32 v[160:161], v[68:69], v[56:57], v[160:161] op_sel:[0,0,0] op_sel_hi:[1,0,1]
    v_pk_fma_f32 v[162:163], v[70:71], v[56:57], v[162:163] op_sel:[0,0,0] op_sel_hi:[1,0,1]
    v_pk_fma_f32 v[164:165], v[72:73], v[56:57], v[164:165] op_sel:[0,0,0] op_sel_hi:[1,0,1]
    v_pk_fma_f32 v[166:167], v[74:75], v[56:57], v[166:167] op_sel:[0,0,0] op_sel_hi:[1,0,1]
    v_pk_fma_f32 v[168:169], v[76:77], v[56:57], v[168:169] op_sel:[0,0,0] op_sel_hi:[1,0,1]
    v_pk_fma_f32 v[170:171], v[78:79], v[56:57], v[170:171] op_sel:[0,0,0] op_sel_hi:[1,0,1]
    v_pk_fma_f32 v[172:173], v[80:81], v[56:57], v[172:173] op_sel:[0,0,0] op_sel_hi:[1,0,1]
    v_pk_fma_f32 v[174:175], v[82:83], v[56:57], v[174:175] op_sel:[0,0,0] op_sel_hi:[1,0,1]
    v_pk_mul_f32 v[160:161], v[160:161], v[84:85]
    v_pk_mul_f32 v[162:163], v[162:163], v[86:87]
    v_pk_mul_f32 v[164:165], v[164:165], v[88:89]
    v_pk_mul_f32 v[166:167], v[166:167], v[90:91]
    v_pk_mul_f32 v[168:169], v[168:169], v[92:93]
    v_pk_mul_f32 v[170:171], v[170:171], v[94:95]
    v_pk_mul_f32 v[172:173], v[172:173], v[96:97]
    v_pk_mul_f32 v[174:175], v[174:175], v[98:99]
    v_cvt_pk_bf16_f32 v100, v160, v161
    v_cvt_pk_bf16_f32 v101, v162, v163
    v_cvt_pk_bf16_f32 v102, v164, v165
    v_cvt_pk_bf16_f32 v103, v166, v167
    v_cvt_pk_bf16_f32 v104, v168, v169
    v_cvt_pk_bf16_f32 v105, v170, v171
    v_cvt_pk_bf16_f32 v106, v172, v173
    v_cvt_pk_bf16_f32 v107, v174, v175
    ds_read_b128 v[68:71], v7 offset:128
    ds_read_b128 v[84:87], v7 offset:640
    ds_read_b128 v[72:75], v7 offset:160
    ds_read_b128 v[88:91], v7 offset:672
    ds_read_b128 v[76:79], v7 offset:192
    ds_read_b128 v[92:95], v7 offset:704
    ds_read_b128 v[80:83], v7 offset:224
    ds_read_b128 v[96:99], v7 offset:736
    ds_write_b128 v9, v[100:103] offset:49152
    buffer_store_dwordx4 v[100:103], v11, s[12:15], s51 offen offset:0 sc1
    ds_write_b128 v9, v[104:107] offset:50176
    buffer_store_dwordx4 v[104:107], v11, s[12:15], s51 offen offset:1024 sc1
    s_waitcnt lgkmcnt(2)
    v_pk_fma_f32 v[208:209], v[68:69], v[56:57], v[208:209] op_sel:[0,0,0] op_sel_hi:[1,0,1]
    v_pk_fma_f32 v[210:211], v[70:71], v[56:57], v[210:211] op_sel:[0,0,0] op_sel_hi:[1,0,1]
    v_pk_fma_f32 v[212:213], v[72:73], v[56:57], v[212:213] op_sel:[0,0,0] op_sel_hi:[1,0,1]
    v_pk_fma_f32 v[214:215], v[74:75], v[56:57], v[214:215] op_sel:[0,0,0] op_sel_hi:[1,0,1]
    v_pk_fma_f32 v[216:217], v[76:77], v[56:57], v[216:217] op_sel:[0,0,0] op_sel_hi:[1,0,1]
    v_pk_fma_f32 v[218:219], v[78:79], v[56:57], v[218:219] op_sel:[0,0,0] op_sel_hi:[1,0,1]
    v_pk_fma_f32 v[220:221], v[80:81], v[56:57], v[220:221] op_sel:[0,0,0] op_sel_hi:[1,0,1]
    v_pk_fma_f32 v[222:223], v[82:83], v[56:57], v[222:223] op_sel:[0,0,0] op_sel_hi:[1,0,1]
    v_pk_mul_f32 v[208:209], v[208:209], v[84:85]
    v_pk_mul_f32 v[210:211], v[210:211], v[86:87]
    v_pk_mul_f32 v[212:213], v[212:213], v[88:89]
    v_pk_mul_f32 v[214:215], v[214:215], v[90:91]
    v_pk_mul_f32 v[216:217], v[216:217], v[92:93]
    v_pk_mul_f32 v[218:219], v[218:219], v[94:95]
    v_pk_mul_f32 v[220:221], v[220:221], v[96:97]
    v_pk_mul_f32 v[222:223], v[222:223], v[98:99]
    v_cvt_pk_bf16_f32 v108, v208, v209
    v_cvt_pk_bf16_f32 v109, v210, v211
    v_cvt_pk_bf16_f32 v110, v212, v213
    v_cvt_pk_bf16_f32 v111, v214, v215
    v_cvt_pk_bf16_f32 v112, v216, v217
    v_cvt_pk_bf16_f32 v113, v218, v219
    v_cvt_pk_bf16_f32 v114, v220, v221
    v_cvt_pk_bf16_f32 v115, v222, v223
    ds_write_b128 v9, v[108:111] offset:51200
    buffer_store_dwordx4 v[108:111], v11, s[12:15], s51 offen offset:2048 sc1
    ds_write_b128 v9, v[112:115] offset:52224
    buffer_store_dwordx4 v[112:115], v11, s[12:15], s51 offen offset:3072 sc1
    v_pk_fma_f32 v[128:129], v[24:25], v[58:59], v[128:129] op_sel:[0,0,0] op_sel_hi:[1,0,1]
    v_pk_fma_f32 v[130:131], v[26:27], v[58:59], v[130:131] op_sel:[0,0,0] op_sel_hi:[1,0,1]
    v_pk_fma_f32 v[132:133], v[28:29], v[58:59], v[132:133] op_sel:[0,0,0] op_sel_hi:[1,0,1]
    v_pk_fma_f32 v[134:135], v[30:31], v[58:59], v[134:135] op_sel:[0,0,0] op_sel_hi:[1,0,1]
    v_pk_fma_f32 v[136:137], v[32:33], v[58:59], v[136:137] op_sel:[0,0,0] op_sel_hi:[1,0,1]
    v_pk_fma_f32 v[138:139], v[34:35], v[58:59], v[138:139] op_sel:[0,0,0] op_sel_hi:[1,0,1]
    v_pk_fma_f32 v[140:141], v[36:37], v[58:59], v[140:141] op_sel:[0,0,0] op_sel_hi:[1,0,1]
    v_pk_fma_f32 v[142:143], v[38:39], v[58:59], v[142:143] op_sel:[0,0,0] op_sel_hi:[1,0,1]
    v_pk_mul_f32 v[128:129], v[128:129], v[62:63] op_sel:[0,1] op_sel_hi:[1,1]
    v_pk_mul_f32 v[130:131], v[130:131], v[62:63] op_sel:[0,1] op_sel_hi:[1,1]
    v_pk_mul_f32 v[132:133], v[132:133], v[62:63] op_sel:[0,1] op_sel_hi:[1,1]
    v_pk_mul_f32 v[134:135], v[134:135], v[62:63] op_sel:[0,1] op_sel_hi:[1,1]
    v_pk_mul_f32 v[136:137], v[136:137], v[62:63] op_sel:[0,1] op_sel_hi:[1,1]
    v_pk_mul_f32 v[138:139], v[138:139], v[62:63] op_sel:[0,1] op_sel_hi:[1,1]
    v_pk_mul_f32 v[140:141], v[140:141], v[62:63] op_sel:[0,1] op_sel_hi:[1,1]
    v_pk_mul_f32 v[142:143], v[142:143], v[62:63] op_sel:[0,1] op_sel_hi:[1,1]
    v_cvt_pk_bf16_f32 v100, v128, v129
    v_cvt_pk_bf16_f32 v101, v130, v131
    v_cvt_pk_bf16_f32 v102, v132, v133
    v_cvt_pk_bf16_f32 v103, v134, v135
    v_cvt_pk_bf16_f32 v104, v136, v137
    v_cvt_pk_bf16_f32 v105, v138, v139
    v_cvt_pk_bf16_f32 v106, v140, v141
    v_cvt_pk_bf16_f32 v107, v142, v143
    ds_write_b128 v10, v[100:103] offset:0
    ds_write_b128 v10, v[104:107] offset:1024
    v_pk_fma_f32 v[176:177], v[24:25], v[60:61], v[176:177] op_sel:[0,0,0] op_sel_hi:[1,0,1]
    v_pk_fma_f32 v[178:179], v[26:27], v[60:61], v[178:179] op_sel:[0,0,0] op_sel_hi:[1,0,1]
    v_pk_fma_f32 v[180:181], v[28:29], v[60:61], v[180:181] op_sel:[0,0,0] op_sel_hi:[1,0,1]
    v_pk_fma_f32 v[182:183], v[30:31], v[60:61], v[182:183] op_sel:[0,0,0] op_sel_hi:[1,0,1]
    v_pk_fma_f32 v[184:185], v[32:33], v[60:61], v[184:185] op_sel:[0,0,0] op_sel_hi:[1,0,1]
    v_pk_fma_f32 v[186:187], v[34:35], v[60:61], v[186:187] op_sel:[0,0,0] op_sel_hi:[1,0,1]
    v_pk_fma_f32 v[188:189], v[36:37], v[60:61], v[188:189] op_sel:[0,0,0] op_sel_hi:[1,0,1]
    v_pk_fma_f32 v[190:191], v[38:39], v[60:61], v[190:191] op_sel:[0,0,0] op_sel_hi:[1,0,1]
    v_pk_mul_f32 v[176:177], v[176:177], v[64:65] op_sel:[0,1] op_sel_hi:[1,1]
    v_pk_mul_f32 v[178:179], v[178:179], v[64:65] op_sel:[0,1] op_sel_hi:[1,1]
    v_pk_mul_f32 v[180:181], v[180:181], v[64:65] op_sel:[0,1] op_sel_hi:[1,1]
    v_pk_mul_f32 v[182:183], v[182:183], v[64:65] op_sel:[0,1] op_sel_hi:[1,1]
    v_pk_mul_f32 v[184:185], v[184:185], v[64:65] op_sel:[0,1] op_sel_hi:[1,1]
    v_pk_mul_f32 v[186:187], v[186:187], v[64:65] op_sel:[0,1] op_sel_hi:[1,1]
    v_pk_mul_f32 v[188:189], v[188:189], v[64:65] op_sel:[0,1] op_sel_hi:[1,1]
    v_pk_mul_f32 v[190:191], v[190:191], v[64:65] op_sel:[0,1] op_sel_hi:[1,1]
    v_cvt_pk_bf16_f32 v108, v176, v177
    v_cvt_pk_bf16_f32 v109, v178, v179
    v_cvt_pk_bf16_f32 v110, v180, v181
    v_cvt_pk_bf16_f32 v111, v182, v183
    v_cvt_pk_bf16_f32 v112, v184, v185
    v_cvt_pk_bf16_f32 v113, v186, v187
    v_cvt_pk_bf16_f32 v114, v188, v189
    v_cvt_pk_bf16_f32 v115, v190, v191
    ds_write_b128 v10, v[108:111] offset:2048
    ds_write_b128 v10, v[112:115] offset:3072
    s_waitcnt lgkmcnt(0)
L_g1_join:
    s_barrier
    s_lshr_b32 s56, s28, 1
    s_and_b32 s56, s56, 1
    s_and_b32 s30, s28, 1
    s_sub_u32 s31, 3, s30
    s_cmp_lt_u32 s28, 4
    s_cselect_b32 s55, s30, s31
    s_cbranch_scc0 L_att_noflag
    s_waitcnt vmcnt(0)
    v_mov_b32 v2, 163584
    v_mov_b32 v3, 1
    v_cmp_eq_u32 vcc, 0, v1
    s_and_saveexec_b64 s[46:47], vcc
    ds_add_rtn_u32 v4, v2, v3
    s_waitcnt lgkmcnt(0)
    s_mov_b64 exec, s[46:47]
    v_readfirstlane_b32 s30, v4
    s_cmp_lg_u32 s30, 3
    s_cbranch_scc1 L_att_noflag
    s_lshl_b32 s30, s34, 14
    s_add_u32 s30, s30, 12593792
    v_mov_b32 v3, 1
    v_cmp_eq_u32 vcc, 0, v1
    s_and_saveexec_b64 s[46:47], vcc
    buffer_store_dword v3, off, s[12:15], s30 sc1
    s_mov_b64 exec, s[46:47]
L_att_noflag:
    v_lshlrev_b32 v2, 4, v1
    s_lshl_b32 s30, s56, 14
    s_lshl_b32 s31, s55, 11
    s_add_u32 s32, s30, s31
    v_add_u32 v208, s32, v2
    v_add_u32 v210, 0, v208
    v_add_u32 v208, 34816, v208
    v_add_u32 v209, s30, v2
    v_add_u32 v209, 90112, v209
    s_lshl_b32 s30, s56, 13
    s_add_u32 s30, s30, s31
    s_add_u32 s30, s30, 73728
    v_add_u32 v3, s30, v2
    ds_read_b128 v[8:11], v3
    ds_read_b128 v[12:15], v3 offset:1024
    v_and_b32 v4, 31, v1
    v_lshrrev_b32 v5, 5, v1
    v_lshlrev_b32 v5, 2, v5
    v_sub_u32 v4, v4, v5
    v_cvt_f32_i32 v200, v4
    v_mov_b32 v201, 0x71800000
    v_mov_b32 v202, 0xf1800000
    v_mov_b32 v144, 0x3f803f80
    v_mov_b32 v145, 0x3f803f80
    v_mov_b32 v146, 0x3f803f80
    v_mov_b32 v147, 0x3f803f80
    s_add_u32 s57, s55, 1
    ds_read_b128 v[16:19], v208 offset:6144
    ds_read_b128 v[20:23], v208 offset:7168
    v_fmaak_f32 v128, v200, v201, 0x00000000
    v_fmaak_f32 v129, v200, v201, 0xf1800000
    v_fmaak_f32 v130, v200, v201, 0xf2000000
    v_fmaak_f32 v131, v200, v201, 0xf2400000
    v_fmaak_f32 v132, v200, v201, 0xf3000000
    v_fmaak_f32 v133, v200, v201, 0xf3100000
    v_fmaak_f32 v134, v200, v201, 0xf3200000
    v_fmaak_f32 v135, v200, v201, 0xf3300000
    v_fmaak_f32 v136, v200, v201, 0xf3800000
    v_fmaak_f32 v137, v200, v201, 0xf3880000
    v_fmaak_f32 v138, v200, v201, 0xf3900000
    v_fmaak_f32 v139, v200, v201, 0xf3980000
    v_fmaak_f32 v140, v200, v201, 0xf3c00000
    v_fmaak_f32 v141, v200, v201, 0xf3c80000
    v_fmaak_f32 v142, v200, v201, 0xf3d00000
    v_fmaak_f32 v143, v200, v201, 0xf3d80000
    v_min_f32 v128, 0, v128
    v_min_f32 v129, 0, v129
    v_min_f32 v130, 0, v130
    v_min_f32 v131, 0, v131
    v_min_f32 v132, 0, v132
    v_min_f32 v133, 0, v133
    v_min_f32 v134, 0, v134
    v_min_f32 v135, 0, v135
    v_min_f32 v136, 0, v136
    v_min_f32 v137, 0, v137
    v_min_f32 v138, 0, v138
    v_min_f32 v139, 0, v139
    v_min_f32 v140, 0, v140
    v_min_f32 v141, 0, v141
    v_min_f32 v142, 0, v142
    v_min_f32 v143, 0, v143
    ds_read_b128 v[24:27], v208 offset:4096
    ds_read_b128 v[28:31], v208 offset:5120
    s_waitcnt lgkmcnt(2)
    v_mfma_f32_32x32x16_bf16 v[80:95], v[16:19], v[8:11], v[128:143]
    v_mfma_f32_32x32x16_bf16 v[80:95], v[20:23], v[12:15], v[80:95]
    s_cmp_eq_u32 s57, 1
    s_cbranch_scc0 L_s1_x1_4
    s_nop 7
    s_nop 3
    v_max3_f32 v204, v80, v81, v82
    v_max3_f32 v205, v83, v84, v85
    v_max3_f32 v204, v86, v87, v204
    v_max3_f32 v205, v88, v89, v205
    v_max3_f32 v204, v90, v91, v204
    v_max3_f32 v205, v92, v93, v205
    v_max3_f32 v204, v94, v95, v204
    s_branch L_s1_p1_2
L_s1_x1_4:
    ds_read_b128 v[16:19], v208 offset:2048
    ds_read_b128 v[20:23], v208 offset:3072
    s_waitcnt lgkmcnt(2)
    v_mfma_f32_32x32x16_bf16 v[96:111], v[24:27], v[8:11], 0
    v_mfma_f32_32x32x16_bf16 v[96:111], v[28:31], v[12:15], v[96:111]
    s_nop 4
    v_max3_f32 v204, v80, v81, v82
    v_max3_f32 v205, v83, v84, v85
    v_max3_f32 v204, v86, v87, v204
    v_max3_f32 v205, v88, v89, v205
    v_max3_f32 v204, v90, v91, v204
    v_max3_f32 v205, v92, v93, v205
    v_max3_f32 v204, v94, v95, v204
    s_cmp_eq_u32 s57, 2
    s_cbranch_scc0 L_s1_x1_5
    s_nop 7
    s_nop 3
    v_max3_f32 v204, v96, v97, v204
    v_max3_f32 v205, v98, v99, v205
    v_max3_f32 v204, v100, v101, v204
    v_max3_f32 v205, v102, v103, v205
    v_max3_f32 v204, v104, v105, v204
    v_max3_f32 v205, v106, v107, v205
    v_max3_f32 v204, v108, v109, v204
    v_max3_f32 v205, v110, v111, v205
    s_branch L_s1_p1_2
L_s1_x1_5:
    ds_read_b128 v[24:27], v208 offset:0
    ds_read_b128 v[28:31], v208 offset:1024
    s_waitcnt lgkmcnt(2)
    v_mfma_f32_32x32x16_bf16 v[80:95], v[16:19], v[8:11], 0
    v_mfma_f32_32x32x16_bf16 v[80:95], v[20:23], v[12:15], v[80:95]
    s_nop 4
    v_max3_f32 v204, v96, v97, v204
    v_max3_f32 v205, v98, v99, v205
    v_max3_f32 v204, v100, v101, v204
    v_max3_f32 v205, v102, v103, v205
    v_max3_f32 v204, v104, v105, v204
    v_max3_f32 v205, v106, v107, v205
    v_max3_f32 v204, v108, v109, v204
    v_max3_f32 v205, v110, v111, v205
    s_cmp_eq_u32 s57, 3
    s_cbranch_scc0 L_s1_x1_6
    s_nop 7
    s_nop 3
    v_max3_f32 v204, v80, v81, v204
    v_max3_f32 v205, v82, v83, v205
    v_max3_f32 v204, v84, v85, v204
    v_max3_f32 v205, v86, v87, v205
    v_max3_f32 v204, v88, v89, v204
    v_max3_f32 v205, v90, v91, v205
    v_max3_f32 v204, v92, v93, v204
    v_max3_f32 v205, v94, v95, v205
    s_branch L_s1_p1_2
L_s1_x1_6:
    s_waitcnt lgkmcnt(0)
    v_mfma_f32_32x32x16_bf16 v[96:111], v[24:27], v[8:11], 0
    v_mfma_f32_32x32x16_bf16 v[96:111], v[28:31], v[12:15], v[96:111]
    s_nop 4
    v_max3_f32 v204, v80, v81, v204
    v_max3_f32 v205, v82, v83, v205
    v_max3_f32 v204, v84, v85, v204
    v_max3_f32 v205, v86, v87, v205
    v_max3_f32 v204, v88, v89, v204
    v_max3_f32 v205, v90, v91, v205
    v_max3_f32 v204, v92, v93, v204
    v_max3_f32 v205, v94, v95, v205
    s_nop 7
    s_nop 3
    v_max3_f32 v204, v96, v97, v204
    v_max3_f32 v205, v98, v99, v205
    v_max3_f32 v204, v100, v101, v204
    v_max3_f32 v205, v102, v103, v205
    v_max3_f32 v204, v104, v105, v204
    v_max3_f32 v205, v106, v107, v205
    v_max3_f32 v204, v108, v109, v204
    v_max3_f32 v205, v110, v111, v205
L_s1_p1_2:
    s_waitcnt lgkmcnt(0)
    ds_read_b128 v[16:19], v208 offset:6144
    ds_read_b128 v[20:23], v208 offset:7168
    ds_read_b128 v[32:35], v208 offset:14336
    ds_read_b128 v[36:39], v208 offset:15360
    v_max_f32 v204, v204, v205
    v_mov_b32 v205, v204
    s_nop 1
    v_permlane32_swap_b32 v205, v204
    v_max_f32 v204, v204, v205
    v_mov_b32 v192, v204
    v_sub_f32 v112, 0, v204
    v_sub_f32 v113, 0, v204
    v_sub_f32 v114, 0, v204
    v_sub_f32 v115, 0, v204
    v_sub_f32 v116, 0, v204
    v_sub_f32 v117, 0, v204
    v_sub_f32 v118, 0, v204
    v_sub_f32 v119, 0, v204
    v_sub_f32 v120, 0, v204
    v_sub_f32 v121, 0, v204
    v_sub_f32 v122, 0, v204
    v_sub_f32 v123, 0, v204
    v_sub_f32 v124, 0, v204
    v_sub_f32 v125, 0, v204
    v_sub_f32 v126, 0, v204
    v_sub_f32 v127, 0, v204
    v_sub_f32 v128, v128, v204
    v_sub_f32 v129, v129, v204
    v_sub_f32 v130, v130, v204
    v_sub_f32 v131, v131, v204
    v_sub_f32 v132, v132, v204
    v_sub_f32 v133, v133, v204
    v_sub_f32 v134, v134, v204
    v_sub_f32 v135, v135, v204
    v_sub_f32 v136, v136, v204
    v_sub_f32 v137, v137, v204
    v_sub_f32 v138, v138, v204
    v_sub_f32 v139, v139, v204
    v_sub_f32 v140, v140, v204
    v_sub_f32 v141, v141, v204
    v_sub_f32 v142, v142, v204
    v_sub_f32 v143, v143, v204
    s_waitcnt lgkmcnt(2)
    s_nop 0
    v_mfma_f32_32x32x16_bf16 v[80:95], v[16:19], v[8:11], v[128:143]
    v_mfma_f32_32x32x16_bf16 v[80:95], v[20:23], v[12:15], v[80:95]
    ds_read_b128 v[24:27], v208 offset:4096
    ds_read_b128 v[28:31], v208 offset:5120
    s_waitcnt lgkmcnt(0)
    v_mfma_f32_32x32x16_bf16 v[96:111], v[24:27], v[8:11], v[112:127]
    v_mfma_f32_32x32x16_bf16 v[96:111], v[28:31], v[12:15], v[96:111]
    s_nop 7
    ds_read_b128 v[16:19], v208 offset:2048
    ds_read_b128 v[20:23], v208 offset:3072
    v_exp_f32 v80, v80
    v_exp_f32 v81, v81
    v_exp_f32 v82, v82
    v_exp_f32 v83, v83
    v_exp_f32 v84, v84
    v_exp_f32 v85, v85
    v_exp_f32 v86, v86
    v_exp_f32 v87, v87
    v_exp_f32 v88, v88
    v_exp_f32 v89, v89
    v_exp_f32 v90, v90
    v_exp_f32 v91, v91
    v_exp_f32 v92, v92
    v_exp_f32 v93, v93
    v_exp_f32 v94, v94
    v_exp_f32 v95, v95
    v_cvt_pk_bf16_f32 v148, v80, v81
    v_cvt_pk_bf16_f32 v149, v82, v83
    v_cvt_pk_bf16_f32 v150, v84, v85
    v_cvt_pk_bf16_f32 v151, v86, v87
    v_cvt_pk_bf16_f32 v152, v88, v89
    v_cvt_pk_bf16_f32 v153, v90, v91
    v_cvt_pk_bf16_f32 v154, v92, v93
    v_cvt_pk_bf16_f32 v155, v94, v95
    s_cmp_eq_u32 s57, 1
    s_cbranch_scc1 L_s1_tail0
    s_waitcnt lgkmcnt(0)
    v_mfma_f32_32x32x16_bf16 v[64:79], v[144:147], v[148:151], 0
    v_exp_f32 v96, v96
    v_exp_f32 v97, v97
    v_exp_f32 v98, v98
    v_mfma_f32_32x32x16_bf16 v[48:63], v[32:35], v[148:151], 0
    v_exp_f32 v99, v99
    v_exp_f32 v100, v100
    v_exp_f32 v101, v101
    v_mfma_f32_32x32x16_bf16 v[64:79], v[144:147], v[152:155], v[64:79]
    v_exp_f32 v102, v102
    v_exp_f32 v103, v103
    v_exp_f32 v104, v104
    v_mfma_f32_32x32x16_bf16 v[48:63], v[36:39], v[152:155], v[48:63]
    v_exp_f32 v105, v105
    v_exp_f32 v106, v106
    v_exp_f32 v107, v107
    ds_read_b128 v[40:43], v208 offset:12288
    ds_read_b128 v[44:47], v208 offset:13312
    ds_read_b128 v[24:27], v208 offset:0
    ds_read_b128 v[28:31], v208 offset:1024
    v_mfma_f32_32x32x16_bf16 v[80:95], v[16:19], v[8:11], v[112:127]
    v_exp_f32 v108, v108
    v_exp_f32 v109, v109
    v_exp_f32 v110, v110
    v_mfma_f32_32x32x16_bf16 v[80:95], v[20:23], v[12:15], v[80:95]
    v_exp_f32 v111, v111
    v_cvt_pk_bf16_f32 v216, v96, v97
    v_cvt_pk_bf16_f32 v217, v98, v99
    v_cvt_pk_bf16_f32 v218, v100, v101
    v_cvt_pk_bf16_f32 v219, v102, v103
    v_cvt_pk_bf16_f32 v220, v104, v105
    v_cvt_pk_bf16_f32 v221, v106, v107
    v_cvt_pk_bf16_f32 v222, v108, v109
    v_cvt_pk_bf16_f32 v223, v110, v111
    s_cmp_eq_u32 s57, 2
    s_cbranch_scc1 L_s1_tail1
    s_waitcnt lgkmcnt(0)
    v_mfma_f32_32x32x16_bf16 v[64:79], v[144:147], v[216:219], v[64:79]
    v_exp_f32 v80, v80
    v_exp_f32 v81, v81
    v_exp_f32 v82, v82
    v_mfma_f32_32x32x16_bf16 v[48:63], v[40:43], v[216:219], v[48:63]
    v_exp_f32 v83, v83
    v_exp_f32 v84, v84
    v_exp_f32 v85, v85
    v_mfma_f32_32x32x16_bf16 v[64:79], v[144:147], v[220:223], v[64:79]
    v_exp_f32 v86, v86
    v_exp_f32 v87, v87
    v_exp_f32 v88, v88
    v_mfma_f32_32x32x16_bf16 v[48:63], v[44:47], v[220:223], v[48:63]
    v_exp_f32 v89, v89
    v_exp_f32 v90, v90
    v_exp_f32 v91, v91
    ds_read_b128 v[32:35], v208 offset:10240
    ds_read_b128 v[36:39], v208 offset:11264
    v_mfma_f32_32x32x16_bf16 v[96:111], v[24:27], v[8:11], v[112:127]
    v_exp_f32 v92, v92
    v_exp_f32 v93, v93
    v_exp_f32 v94, v94
    v_mfma_f32_32x32x16_bf16 v[96:111], v[28:31], v[12:15], v[96:111]
    v_exp_f32 v95, v95
    v_cvt_pk_bf16_f32 v148, v80, v81
    v_cvt_pk_bf16_f32 v149, v82, v83
    v_cvt_pk_bf16_f32 v150, v84, v85
    v_cvt_pk_bf16_f32 v151, v86, v87
    v_cvt_pk_bf16_f32 v152, v88, v89
    v_cvt_pk_bf16_f32 v153, v90, v91
    v_cvt_pk_bf16_f32 v154, v92, v93
    v_cvt_pk_bf16_f32 v155, v94, v95
    s_cmp_eq_u32 s57, 3
    s_cbranch_scc1 L_s1_tail2
    s_waitcnt lgkmcnt(0)
    v_mfma_f32_32x32x16_bf16 v[64:79], v[144:147], v[148:151], v[64:79]
    v_exp_f32 v96, v96
    v_exp_f32 v97, v97
    v_exp_f32 v98, v98
    v_mfma_f32_32x32x16_bf16 v[48:63], v[32:35], v[148:151], v[48:63]
    v_exp_f32 v99, v99
    v_exp_f32 v100, v100
    v_exp_f32 v101, v101
    v_mfma_f32_32x32x16_bf16 v[64:79], v[144:147], v[152:155], v[64:79]
    v_exp_f32 v102, v102
    v_exp_f32 v103, v103
    v_exp_f32 v104, v104
    v_mfma_f32_32x32x16_bf16 v[48:63], v[36:39], v[152:155], v[48:63]
    v_exp_f32 v105, v105
    v_exp_f32 v106, v106
    v_exp_f32 v107, v107
    v_exp_f32 v108, v108
    v_exp_f32 v109, v109
    v_exp_f32 v110, v110
    v_exp_f32 v111, v111
    ds_read_b128 v[40:43], v208 offset:8192
    ds_read_b128 v[44:47], v208 offset:9216
    v_cvt_pk_bf16_f32 v216, v96, v97
    v_cvt_pk_bf16_f32 v217, v98, v99
    v_cvt_pk_bf16_f32 v218, v100, v101
    v_cvt_pk_bf16_f32 v219, v102, v103
    v_cvt_pk_bf16_f32 v220, v104, v105
    v_cvt_pk_bf16_f32 v221, v106, v107
    v_cvt_pk_bf16_f32 v222, v108, v109
    v_cvt_pk_bf16_f32 v223, v110, v111
L_s1_tail3:
    s_waitcnt lgkmcnt(0)
    s_nop 0
    v_mfma_f32_32x32x16_bf16 v[64:79], v[144:147], v[216:219], v[64:79]
    v_mfma_f32_32x32x16_bf16 v[48:63], v[40:43], v[216:219], v[48:63]
    v_mfma_f32_32x32x16_bf16 v[64:79], v[144:147], v[220:223], v[64:79]
    v_mfma_f32_32x32x16_bf16 v[48:63], v[44:47], v[220:223], v[48:63]
    s_branch L_s1_p2_3
L_s1_tail2:
    s_waitcnt lgkmcnt(0)
    s_nop 0
    v_mfma_f32_32x32x16_bf16 v[64:79], v[144:147], v[148:151], v[64:79]
    v_mfma_f32_32x32x16_bf16 v[48:63], v[32:35], v[148:151], v[48:63]
    v_mfma_f32_32x32x16_bf16 v[64:79], v[144:147], v[152:155], v[64:79]
    v_mfma_f32_32x32x16_bf16 v[48:63], v[36:39], v[152:155], v[48:63]
    s_branch L_s1_p2_3
L_s1_tail1:
    s_waitcnt lgkmcnt(0)
    s_nop 0
    v_mfma_f32_32x32x16_bf16 v[64:79], v[144:147], v[216:219], v[64:79]
    v_mfma_f32_32x32x16_bf16 v[48:63], v[40:43], v[216:219], v[48:63]
    v_mfma_f32_32x32x16_bf16 v[64:79], v[144:147], v[220:223], v[64:79]
    v_mfma_f32_32x32x16_bf16 v[48:63], v[44:47], v[220:223], v[48:63]
    s_branch L_s1_p2_3
L_s1_tail0:
    s_waitcnt lgkmcnt(0)
    s_nop 0
    v_mfma_f32_32x32x16_bf16 v[64:79], v[144:147], v[148:151], 0
    v_mfma_f32_32x32x16_bf16 v[48:63], v[32:35], v[148:151], 0
    v_mfma_f32_32x32x16_bf16 v[64:79], v[144:147], v[152:155], v[64:79]
    v_mfma_f32_32x32x16_bf16 v[48:63], v[36:39], v[152:155], v[48:63]
L_s1_p2_3:
    s_cmp_ge_u32 s28, 4
    s_cbranch_scc1 L_att_pre
    s_and_b32 s48, s28, 1
    s_add_u32 s30, s48, 1
    s_cmp_lt_u32 s26, s30
    s_cbranch_scc1 L_att_pre
    s_sub_u32 s49, s26, s30
    s_lshl_b32 s49, s49, 4
    s_add_u32 s49, s49, s27
    s_lshl_b32 s50, s49, 14
    s_add_u32 s50, s50, 12593792
    s_mov_b32 s33, 400000
L_poll_10:
    buffer_load_dword v2, off, s[12:15], s50 sc1
    s_waitcnt vmcnt(0)
    v_readfirstlane_b32 s32, v2
    s_cmp_eq_u32 s32, 1
    s_cbranch_scc1 L_poll_10_ok
    s_sleep 1
    s_sub_u32 s33, s33, 1
    s_cmp_lg_u32 s33, 0
    s_cbranch_scc1 L_poll_10
    s_mov_b32 s54, 2
L_poll_10_ok:
    s_lshl_b32 s50, s49, 15
    s_lshl_b32 s30, s56, 14
    s_add_u32 s50, s50, s30
    s_add_u32 s50, s50, 0
    s_cmp_eq_u32 s48, 0
    s_cselect_b32 s51, 90112, 0
    s_add_u32 s51, s51, s30
    v_lshlrev_b32 v2, 4, v1
    s_mov_b32 m0, s51
    s_add_u32 s51, s51, 4096
    buffer_load_dwordx4 v2, s[12:15], s50 offen sc1 lds
    buffer_load_dwordx4 v2, s[12:15], s50 offen offset:1024 sc1 lds
    buffer_load_dwordx4 v2, s[12:15], s50 offen offset:2048 sc1 lds
    buffer_load_dwordx4 v2, s[12:15], s50 offen offset:3072 sc1 lds
    s_add_u32 s50, s50, 4096
    s_mov_b32 m0, s51
    s_add_u32 s51, s51, 4096
    buffer_load_dwordx4 v2, s[12:15], s50 offen sc1 lds
    buffer_load_dwordx4 v2, s[12:15], s50 offen offset:1024 sc1 lds
    buffer_load_dwordx4 v2, s[12:15], s50 offen offset:2048 sc1 lds
    buffer_load_dwordx4 v2, s[12:15], s50 offen offset:3072 sc1 lds
    s_add_u32 s50, s50, 4096
    s_mov_b32 m0, s51
    s_add_u32 s51, s51, 4096
    buffer_load_dwordx4 v2, s[12:15], s50 offen sc1 lds
    buffer_load_dwordx4 v2, s[12:15], s50 offen offset:1024 sc1 lds
    buffer_load_dwordx4 v2, s[12:15], s50 offen offset:2048 sc1 lds
    buffer_load_dwordx4 v2, s[12:15], s50 offen offset:3072 sc1 lds
    s_add_u32 s50, s50, 4096
    s_mov_b32 m0, s51
    s_add_u32 s51, s51, 4096
    buffer_load_dwordx4 v2, s[12:15], s50 offen sc1 lds
    buffer_load_dwordx4 v2, s[12:15], s50 offen offset:1024 sc1 lds
    buffer_load_dwordx4 v2, s[12:15], s50 offen offset:2048 sc1 lds
    buffer_load_dwordx4 v2, s[12:15], s50 offen offset:3072 sc1 lds
    s_add_u32 s50, s50, 4096
L_att_pre:
    s_load_dwordx2 s[20:21], s[0:1], 48
    s_mov_b32 s22, 7340032
    s_mov_b32 s23, 0x20000
    v_lshrrev_b32 v2, 3, v1
    v_lshrrev_b32 v3, 4, v1
    v_and_b32 v3, 3, v3
    v_lshlrev_b32 v3, 1, v3
    v_and_b32 v4, 7, v1
    v_xor_b32 v3, v3, v4
    v_mul_u32_u24 v2, 7168, v2
    v_lshl_add_u32 v212, v3, 4, v2
    s_min_u32 s32, s34, 223
    s_and_b32 s31, s32, 3
    s_lshl_b32 s31, s31, 2
    s_add_u32 s31, s31, s29
    s_mul_i32 s63, s31, 458752
    s_lshr_b32 s31, s32, 2
    s_lshl_b32 s31, s31, 7
    s_add_u32 s63, s63, s31
    s_lshl_b32 s62, s29, 13
    s_add_u32 s62, s62, 40960
    s_waitcnt lgkmcnt(0)
    s_load_dwordx2 s[60:61], s[0:1], 32
    s_load_dwordx2 s[50:51], s[0:1], 16
    s_load_dwordx2 s[52:53], s[0:1], 56
    s_min_u32 s30, s34, 223
    s_lshl_b32 s30, s30, 15
    v_lshl_add_u32 v213, v0, 2, s30
    s_lshr_b32 s30, s27, 3
    s_lshl_b32 s58, s26, 1
    s_add_u32 s58, s58, s30
    s_and_b32 s59, s27, 7
    v_and_b32 v2, 31, v1
    v_lshrrev_b32 v3, 5, v1
    s_lshl_b32 s30, s59, 8
    s_lshl_b32 s31, s29, 6
    s_add_u32 s30, s30, s31
    v_lshl_add_u32 v231, v3, 3, s30
    v_lshl_add_u32 v4, v3, 4, s30
    v_lshl_add_u32 v230, v2, 11, v4
    s_lshl_b32 s48, s58, 17
    s_add_u32 s49, s48, 65536
    s_and_b32 s30, s26, 7
    s_lshl_b32 s30, s30, 2
    s_and_b32 s31, s27, 3
    s_add_u32 s30, s30, s31
    s_lshl_b32 s30, s30, 2
    s_add_u32 s30, s30, s29
    s_lshl_b32 s30, s30, 14
    s_lshr_b32 s31, s27, 2
    s_and_b32 s31, s31, 1
    s_lshl_b32 s31, s31, 10
    s_add_u32 s30, s30, s31
    v_lshrrev_b32 v4, 3, v1
    v_lshlrev_b32 v4, 11, v4
    v_and_b32 v5, 7, v1
    v_lshl_add_u32 v4, v5, 7, v4
    v_add_u32 v211, s30, v4
    s_waitcnt lgkmcnt(0)
    v_fmaak_f32 v128, v200, v202, 0xf1000000
    v_fmaak_f32 v129, v200, v202, 0x71000000
    v_fmaak_f32 v130, v200, v202, 0x71c00000
    v_fmaak_f32 v131, v200, v202, 0x72200000
    v_fmaak_f32 v132, v200, v202, 0x72f00000
    v_fmaak_f32 v133, v200, v202, 0x73080000
    v_fmaak_f32 v134, v200, v202, 0x73180000
    v_fmaak_f32 v135, v200, v202, 0x73280000
    v_fmaak_f32 v136, v200, v202, 0x73780000
    v_fmaak_f32 v137, v200, v202, 0x73840000
    v_fmaak_f32 v138, v200, v202, 0x738c0000
    v_fmaak_f32 v139, v200, v202, 0x73940000
    v_fmaak_f32 v140, v200, v202, 0x73bc0000
    v_fmaak_f32 v141, v200, v202, 0x73c40000
    v_fmaak_f32 v142, v200, v202, 0x73cc0000
    v_fmaak_f32 v143, v200, v202, 0x73d40000
    v_min_f32 v128, 0, v128
    v_min_f32 v129, 0, v129
    v_min_f32 v130, 0, v130
    v_min_f32 v131, 0, v131
    v_min_f32 v132, 0, v132
    v_min_f32 v133, 0, v133
    v_min_f32 v134, 0, v134
    v_min_f32 v135, 0, v135
    v_min_f32 v136, 0, v136
    v_min_f32 v137, 0, v137
    v_min_f32 v138, 0, v138
    v_min_f32 v139, 0, v139
    v_min_f32 v140, 0, v140
    v_min_f32 v141, 0, v141
    v_min_f32 v142, 0, v142
    v_min_f32 v143, 0, v143
    s_nop 7
    v_sub_f32 v128, v128, v192
    v_sub_f32 v129, v129, v192
    v_sub_f32 v130, v130, v192
    v_sub_f32 v131, v131, v192
    v_sub_f32 v132, v132, v192
    v_sub_f32 v133, v133, v192
    v_sub_f32 v134, v134, v192
    v_sub_f32 v135, v135, v192
    v_sub_f32 v136, v136, v192
    v_sub_f32 v137, v137, v192
    v_sub_f32 v138, v138, v192
    v_sub_f32 v139, v139, v192
    v_sub_f32 v140, v140, v192
    v_sub_f32 v141, v141, v192
    v_sub_f32 v142, v142, v192
    v_sub_f32 v143, v143, v192
    v_mov_b32 v232, v48
    v_mov_b32 v233, v49
    v_mov_b32 v234, v50
    v_mov_b32 v235, v51
    v_mov_b32 v236, v52
    v_mov_b32 v237, v53
    v_mov_b32 v238, v54
    v_mov_b32 v239, v55
    v_mov_b32 v240, v56
    v_mov_b32 v241, v57
    v_mov_b32 v242, v58
    v_mov_b32 v243, v59
    v_mov_b32 v244, v60
    v_mov_b32 v245, v61
    v_mov_b32 v246, v62
    v_mov_b32 v247, v63
    v_mov_b32 v156, v64
    s_waitcnt vmcnt(0)
    s_barrier
    s_cmp_lt_u32 s28, 4
    s_cbranch_scc1 L_gfr_11
    v_lshrrev_b32 v2, 4, v1
    v_and_b32 v3, 15, v1
    v_lshrrev_b32 v4, 2, v3
    v_lshl_add_u32 v4, v2, 2, v4
    v_lshrrev_b32 v5, 1, v4
    v_and_b32 v5, 3, v5
    v_xor_b32 v5, s29, v5
    v_lshlrev_b32 v4, 7, v4
    v_lshl_add_u32 v4, v5, 5, v4
    v_and_b32 v5, 3, v1
    v_lshl_add_u32 v4, v5, 3, v4
    v_add_u32 v4, 122880, v4
    ds_read_b64_tr_b16 v[160:161], v4 offset:0
    ds_read_b64_tr_b16 v[162:163], v4 offset:2048
    ds_read_b64_tr_b16 v[164:165], v4 offset:4096
    ds_read_b64_tr_b16 v[166:167], v4 offset:6144
    ds_read_b64_tr_b16 v[168:169], v4 offset:8192
    ds_read_b64_tr_b16 v[170:171], v4 offset:10240
    ds_read_b64_tr_b16 v[172:173], v4 offset:12288
    ds_read_b64_tr_b16 v[174:175], v4 offset:14336
    s_waitcnt lgkmcnt(0)
    ds_read_b64_tr_b16 v[176:177], v4 offset:16384
    ds_read_b64_tr_b16 v[178:179], v4 offset:18432
    ds_read_b64_tr_b16 v[180:181], v4 offset:20480
    ds_read_b64_tr_b16 v[182:183], v4 offset:22528
    ds_read_b64_tr_b16 v[184:185], v4 offset:24576
    ds_read_b64_tr_b16 v[186:187], v4 offset:26624
    ds_read_b64_tr_b16 v[188:189], v4 offset:28672
    ds_read_b64_tr_b16 v[190:191], v4 offset:30720
    s_waitcnt lgkmcnt(0)
L_gfr_11:
    s_cmp_eq_u32 s26, 0
    s_cbranch_scc1 L_att_rb0
    s_sub_u32 s57, 8, s55
    s_cmp_eq_u32 s26, 1
    s_cselect_b32 s57, 4, s57
    s_cmp_lt_u32 s28, 4
    s_cbranch_scc1 L_side_12_c
    s_mov_b32 m0, s62
    s_add_u32 s62, s62, 1024
    buffer_load_dwordx4 v212, s[20:23], s63 offen nt lds
    s_add_u32 s63, s63, 57344
    s_mov_b32 m0, s62
    s_add_u32 s62, s62, 1024
    buffer_load_dwordx4 v212, s[20:23], s63 offen nt lds
    s_add_u32 s63, s63, 57344
    s_branch L_side_12_j
L_side_12_c:
    global_load_dwordx2 v[248:249], v231, s[60:61]
    global_load_dwordx2 v[250:251], v231, s[60:61] offset:16
    global_load_dwordx2 v[252:253], v231, s[60:61] offset:32
    global_load_dwordx2 v[254:255], v231, s[60:61] offset:48
L_side_12_j:
    s_cmp_lt_u32 s28, 4
    s_cbranch_scc1 L_side_13_c
    s_mov_b32 m0, s62
    s_add_u32 s62, s62, 1024
    buffer_load_dwordx4 v212, s[20:23], s63 offen nt lds
    s_add_u32 s63, s63, 57344
    s_mov_b32 m0, s62
    s_add_u32 s62, s62, 1024
    buffer_load_dwordx4 v212, s[20:23], s63 offen nt lds
    s_add_u32 s63, s63, 57344
    s_branch L_side_13_j
L_side_13_c:
L_side_13_j:
    s_cmp_lt_u32 s28, 4
    s_cbranch_scc1 L_side_14_c
    s_mov_b32 m0, s62
    s_add_u32 s62, s62, 1024
    buffer_load_dwordx4 v212, s[20:23], s63 offen nt lds
    s_add_u32 s63, s63, 57344
    s_mov_b32 m0, s62
    s_add_u32 s62, s62, 1024
    buffer_load_dwordx4 v212, s[20:23], s63 offen nt lds
    s_add_u32 s63, s63, 57344
    global_load_dword v255, v211, s[50:51]
    s_branch L_side_14_j
L_side_14_c:
L_side_14_j:
    s_cmp_lt_u32 s28, 4
    s_cbranch_scc1 L_side_15_c
    s_mov_b32 m0, s62
    s_add_u32 s62, s62, 1024
    buffer_load_dwordx4 v212, s[20:23], s63 offen nt lds
    s_add_u32 s63, s63, 57344
    s_mov_b32 m0, s62
    s_add_u32 s62, s62, 1024
    buffer_load_dwordx4 v212, s[20:23], s63 offen nt lds
    s_add_u32 s63, s63, 57344
    s_branch L_side_15_j
L_side_15_c:
L_side_15_j:
    ds_read_b128 v[16:19], v209 offset:0
    ds_read_b128 v[20:23], v209 offset:1024
    ds_read_b128 v[32:35], v209 offset:8192
    ds_read_b128 v[36:39], v209 offset:9216
    s_waitcnt lgkmcnt(2)
    s_nop 0
    v_mfma_f32_32x32x16_bf16 v[80:95], v[16:19], v[8:11], v[112:127]
    v_mfma_f32_32x32x16_bf16 v[80:95], v[20:23], v[12:15], v[80:95]
    ds_read_b128 v[24:27], v209 offset:2048
    ds_read_b128 v[28:31], v209 offset:3072
    s_waitcnt lgkmcnt(0)
    v_mfma_f32_32x32x16_bf16 v[96:111], v[24:27], v[8:11], v[112:127]
    v_mfma_f32_32x32x16_bf16 v[96:111], v[28:31], v[12:15], v[96:111]
    s_nop 7
    ds_read_b128 v[16:19], v209 offset:4096
    ds_read_b128 v[20:23], v209 offset:5120
    v_exp_f32 v80, v80
    v_exp_f32 v81, v81
    v_exp_f32 v82, v82
    v_exp_f32 v83, v83
    v_exp_f32 v84, v84
    v_exp_f32 v85, v85
    v_exp_f32 v86, v86
    v_exp_f32 v87, v87
    v_exp_f32 v88, v88
    v_exp_f32 v89, v89
    v_exp_f32 v90, v90
    v_exp_f32 v91, v91
    v_exp_f32 v92, v92
    v_exp_f32 v93, v93
    v_exp_f32 v94, v94
    v_exp_f32 v95, v95
    v_cvt_pk_bf16_f32 v148, v80, v81
    v_cvt_pk_bf16_f32 v149, v82, v83
    v_cvt_pk_bf16_f32 v150, v84, v85
    v_cvt_pk_bf16_f32 v151, v86, v87
    v_cvt_pk_bf16_f32 v152, v88, v89
    v_cvt_pk_bf16_f32 v153, v90, v91
    v_cvt_pk_bf16_f32 v154, v92, v93
    v_cvt_pk_bf16_f32 v155, v94, v95
    s_cmp_eq_u32 s57, 1
    s_cbranch_scc1 L_s2_tail0
    s_waitcnt lgkmcnt(0)
    v_mfma_f32_32x32x16_bf16 v[64:79], v[144:147], v[148:151], v[64:79]
    v_exp_f32 v96, v96
    v_exp_f32 v97, v97
    v_exp_f32 v98, v98
    v_mfma_f32_32x32x16_bf16 v[48:63], v[32:35], v[148:151], v[48:63]
    v_exp_f32 v99, v99
    v_exp_f32 v100, v100
    v_exp_f32 v101, v101
    v_mfma_f32_32x32x16_bf16 v[64:79], v[144:147], v[152:155], v[64:79]
    v_exp_f32 v102, v102
    v_exp_f32 v103, v103
    v_exp_f32 v104, v104
    v_mfma_f32_32x32x16_bf16 v[48:63], v[36:39], v[152:155], v[48:63]
    v_exp_f32 v105, v105
    v_exp_f32 v106, v106
    v_exp_f32 v107, v107
    ds_read_b128 v[40:43], v209 offset:10240
    ds_read_b128 v[44:47], v209 offset:11264
    ds_read_b128 v[24:27], v209 offset:6144
    ds_read_b128 v[28:31], v209 offset:7168
    v_mfma_f32_32x32x16_bf16 v[80:95], v[16:19], v[8:11], v[112:127]
    v_exp_f32 v108, v108
    v_exp_f32 v109, v109
    v_exp_f32 v110, v110
    v_mfma_f32_32x32x16_bf16 v[80:95], v[20:23], v[12:15], v[80:95]
    v_exp_f32 v111, v111
    v_cvt_pk_bf16_f32 v216, v96, v97
    v_cvt_pk_bf16_f32 v217, v98, v99
    v_cvt_pk_bf16_f32 v218, v100, v101
    v_cvt_pk_bf16_f32 v219, v102, v103
    v_cvt_pk_bf16_f32 v220, v104, v105
    v_cvt_pk_bf16_f32 v221, v106, v107
    v_cvt_pk_bf16_f32 v222, v108, v109
    v_cvt_pk_bf16_f32 v223, v110, v111
    s_cmp_eq_u32 s57, 2
    s_cbranch_scc1 L_s2_tail1
    s_waitcnt lgkmcnt(0)
    v_mfma_f32_32x32x16_bf16 v[64:79], v[144:147], v[216:219], v[64:79]
    v_exp_f32 v80, v80
    v_exp_f32 v81, v81
    v_exp_f32 v82, v82
    v_mfma_f32_32x32x16_bf16 v[48:63], v[40:43], v[216:219], v[48:63]
    v_exp_f32 v83, v83
    v_exp_f32 v84, v84
    v_exp_f32 v85, v85
    v_mfma_f32_32x32x16_bf16 v[64:79], v[144:147], v[220:223], v[64:79]
    v_exp_f32 v86, v86
    v_exp_f32 v87, v87
    v_exp_f32 v88, v88
    v_mfma_f32_32x32x16_bf16 v[48:63], v[44:47], v[220:223], v[48:63]
    v_exp_f32 v89, v89
    v_exp_f32 v90, v90
    v_exp_f32 v91, v91
    ds_read_b128 v[32:35], v209 offset:12288
    ds_read_b128 v[36:39], v209 offset:13312
    ds_read_b128 v[16:19], v210 offset:0
    ds_read_b128 v[20:23], v210 offset:1024
    v_mfma_f32_32x32x16_bf16 v[96:111], v[24:27], v[8:11], v[112:127]
    v_exp_f32 v92, v92
    v_exp_f32 v93, v93
    v_exp_f32 v94, v94
    v_mfma_f32_32x32x16_bf16 v[96:111], v[28:31], v[12:15], v[96:111]
    v_exp_f32 v95, v95
    v_cvt_pk_bf16_f32 v148, v80, v81
    v_cvt_pk_bf16_f32 v149, v82, v83
    v_cvt_pk_bf16_f32 v150, v84, v85
    v_cvt_pk_bf16_f32 v151, v86, v87
    v_cvt_pk_bf16_f32 v152, v88, v89
    v_cvt_pk_bf16_f32 v153, v90, v91
    v_cvt_pk_bf16_f32 v154, v92, v93
    v_cvt_pk_bf16_f32 v155, v94, v95
    s_cmp_eq_u32 s57, 3
    s_cbranch_scc1 L_s2_tail2
    s_waitcnt lgkmcnt(0)
    v_mfma_f32_32x32x16_bf16 v[64:79], v[144:147], v[148:151], v[64:79]
    v_exp_f32 v96, v96
    v_exp_f32 v97, v97
    v_exp_f32 v98, v98
    v_mfma_f32_32x32x16_bf16 v[48:63], v[32:35], v[148:151], v[48:63]
    v_exp_f32 v99, v99
    v_exp_f32 v100, v100
    v_exp_f32 v101, v101
    v_mfma_f32_32x32x16_bf16 v[64:79], v[144:147], v[152:155], v[64:79]
    v_exp_f32 v102, v102
    v_exp_f32 v103, v103
    v_exp_f32 v104, v104
    v_mfma_f32_32x32x16_bf16 v[48:63], v[36:39], v[152:155], v[48:63]
    v_exp_f32 v105, v105
    v_exp_f32 v106, v106
    v_exp_f32 v107, v107
    ds_read_b128 v[40:43], v209 offset:14336
    ds_read_b128 v[44:47], v209 offset:15360
    ds_read_b128 v[24:27], v210 offset:2048
    ds_read_b128 v[28:31], v210 offset:3072
    v_mfma_f32_32x32x16_bf16 v[80:95], v[16:19], v[8:11], v[128:143]
    v_exp_f32 v108, v108
    v_exp_f32 v109, v109
    v_exp_f32 v110, v110
    v_mfma_f32_32x32x16_bf16 v[80:95], v[20:23], v[12:15], v[80:95]
    v_exp_f32 v111, v111
    v_cvt_pk_bf16_f32 v216, v96, v97
    v_cvt_pk_bf16_f32 v217, v98, v99
    v_cvt_pk_bf16_f32 v218, v100, v101
    v_cvt_pk_bf16_f32 v219, v102, v103
    v_cvt_pk_bf16_f32 v220, v104, v105
    v_cvt_pk_bf16_f32 v221, v106, v107
    v_cvt_pk_bf16_f32 v222, v108, v109
    v_cvt_pk_bf16_f32 v223, v110, v111
    s_cmp_eq_u32 s57, 4
    s_cbranch_scc1 L_s2_tail3
    s_waitcnt lgkmcnt(0)
    v_mfma_f32_32x32x16_bf16 v[64:79], v[144:147], v[216:219], v[64:79]
    v_exp_f32 v80, v80
    v_exp_f32 v81, v81
    v_exp_f32 v82, v82
    v_mfma_f32_32x32x16_bf16 v[48:63], v[40:43], v[216:219], v[48:63]
    v_exp_f32 v83, v83
    v_exp_f32 v84, v84
    v_exp_f32 v85, v85
    v_mfma_f32_32x32x16_bf16 v[64:79], v[144:147], v[220:223], v[64:79]
    v_exp_f32 v86, v86
    v_exp_f32 v87, v87
    v_exp_f32 v88, v88
    v_mfma_f32_32x32x16_bf16 v[48:63], v[44:47], v[220:223], v[48:63]
    v_exp_f32 v89, v89
    v_exp_f32 v90, v90
    v_exp_f32 v91, v91
    ds_read_b128 v[32:35], v210 offset:8192
    ds_read_b128 v[36:39], v210 offset:9216
    ds_read_b128 v[16:19], v210 offset:4096
    ds_read_b128 v[20:23], v210 offset:5120
    v_mfma_f32_32x32x16_bf16 v[96:111], v[24:27], v[8:11], v[112:127]
    v_exp_f32 v92, v92
    v_exp_f32 v93, v93
    v_exp_f32 v94, v94
    v_mfma_f32_32x32x16_bf16 v[96:111], v[28:31], v[12:15], v[96:111]
    v_exp_f32 v95, v95
    v_cvt_pk_bf16_f32 v148, v80, v81
    v_cvt_pk_bf16_f32 v149, v82, v83
    v_cvt_pk_bf16_f32 v150, v84, v85
    v_cvt_pk_bf16_f32 v151, v86, v87
    v_cvt_pk_bf16_f32 v152, v88, v89
    v_cvt_pk_bf16_f32 v153, v90, v91
    v_cvt_pk_bf16_f32 v154, v92, v93
    v_cvt_pk_bf16_f32 v155, v94, v95
    s_cmp_eq_u32 s57, 5
    s_cbranch_scc1 L_s2_tail4
    s_waitcnt lgkmcnt(0)
    v_mfma_f32_32x32x16_bf16 v[64:79], v[144:147], v[148:151], v[64:79]
    v_exp_f32 v96, v96
    v_exp_f32 v97, v97
    v_exp_f32 v98, v98
    v_mfma_f32_32x32x16_bf16 v[48:63], v[32:35], v[148:151], v[48:63]
    v_exp_f32 v99, v99
    v_exp_f32 v100, v100
    v_exp_f32 v101, v101
    v_mfma_f32_32x32x16_bf16 v[64:79], v[144:147], v[152:155], v[64:79]
    v_exp_f32 v102, v102
    v_exp_f32 v103, v103
    v_exp_f32 v104, v104
    v_mfma_f32_32x32x16_bf16 v[48:63], v[36:39], v[152:155], v[48:63]
    v_exp_f32 v105, v105
    v_exp_f32 v106, v106
    v_exp_f32 v107, v107
    ds_read_b128 v[40:43], v210 offset:10240
    ds_read_b128 v[44:47], v210 offset:11264
    ds_read_b128 v[24:27], v210 offset:6144
    ds_read_b128 v[28:31], v210 offset:7168
    v_mfma_f32_32x32x16_bf16 v[80:95], v[16:19], v[8:11], v[112:127]
    v_exp_f32 v108, v108
    v_exp_f32 v109, v109
    v_exp_f32 v110, v110
    v_mfma_f32_32x32x16_bf16 v[80:95], v[20:23], v[12:15], v[80:95]
    v_exp_f32 v111, v111
    v_cvt_pk_bf16_f32 v216, v96, v97
    v_cvt_pk_bf16_f32 v217, v98, v99
    v_cvt_pk_bf16_f32 v218, v100, v101
    v_cvt_pk_bf16_f32 v219, v102, v103
    v_cvt_pk_bf16_f32 v220, v104, v105
    v_cvt_pk_bf16_f32 v221, v106, v107
    v_cvt_pk_bf16_f32 v222, v108, v109
    v_cvt_pk_bf16_f32 v223, v110, v111
    s_cmp_eq_u32 s57, 6
    s_cbranch_scc1 L_s2_tail5
    s_waitcnt lgkmcnt(0)
    v_mfma_f32_32x32x16_bf16 v[64:79], v[144:147], v[216:219], v[64:79]
    v_exp_f32 v80, v80
    v_exp_f32 v81, v81
    v_exp_f32 v82, v82
    v_mfma_f32_32x32x16_bf16 v[48:63], v[40:43], v[216:219], v[48:63]
    v_exp_f32 v83, v83
    v_exp_f32 v84, v84
    v_exp_f32 v85, v85
    v_mfma_f32_32x32x16_bf16 v[64:79], v[144:147], v[220:223], v[64:79]
    v_exp_f32 v86, v86
    v_exp_f32 v87, v87
    v_exp_f32 v88, v88
    v_mfma_f32_32x32x16_bf16 v[48:63], v[44:47], v[220:223], v[48:63]
    v_exp_f32 v89, v89
    v_exp_f32 v90, v90
    v_exp_f32 v91, v91
    ds_read_b128 v[32:35], v210 offset:12288
    ds_read_b128 v[36:39], v210 offset:13312
    v_mfma_f32_32x32x16_bf16 v[96:111], v[24:27], v[8:11], v[112:127]
    v_exp_f32 v92, v92
    v_exp_f32 v93, v93
    v_exp_f32 v94, v94
    v_mfma_f32_32x32x16_bf16 v[96:111], v[28:31], v[12:15], v[96:111]
    v_exp_f32 v95, v95
    v_cvt_pk_bf16_f32 v148, v80, v81
    v_cvt_pk_bf16_f32 v149, v82, v83
    v_cvt_pk_bf16_f32 v150, v84, v85
    v_cvt_pk_bf16_f32 v151, v86, v87
    v_cvt_pk_bf16_f32 v152, v88, v89
    v_cvt_pk_bf16_f32 v153, v90, v91
    v_cvt_pk_bf16_f32 v154, v92, v93
    v_cvt_pk_bf16_f32 v155, v94, v95
    s_cmp_eq_u32 s57, 7
    s_cbranch_scc1 L_s2_tail6
    s_waitcnt lgkmcnt(0)
    v_mfma_f32_32x32x16_bf16 v[64:79], v[144:147], v[148:151], v[64:79]
    v_exp_f32 v96, v96
    v_exp_f32 v97, v97
    v_exp_f32 v98, v98
    v_mfma_f32_32x32x16_bf16 v[48:63], v[32:35], v[148:151], v[48:63]
    v_exp_f32 v99, v99
    v_exp_f32 v100, v100
    v_exp_f32 v101, v101
    v_mfma_f32_32x32x16_bf16 v[64:79], v[144:147], v[152:155], v[64:79]
    v_exp_f32 v102, v102
    v_exp_f32 v103, v103
    v_exp_f32 v104, v104
    v_mfma_f32_32x32x16_bf16 v[48:63], v[36:39], v[152:155], v[48:63]
    v_exp_f32 v105, v105
    v_exp_f32 v106, v106
    v_exp_f32 v107, v107
    v_exp_f32 v108, v108
    v_exp_f32 v109, v109
    v_exp_f32 v110, v110
    v_exp_f32 v111, v111
    ds_read_b128 v[40:43], v210 offset:14336
    ds_read_b128 v[44:47], v210 offset:15360
    v_cvt_pk_bf16_f32 v216, v96, v97
    v_cvt_pk_bf16_f32 v217, v98, v99
    v_cvt_pk_bf16_f32 v218, v100, v101
    v_cvt_pk_bf16_f32 v219, v102, v103
    v_cvt_pk_bf16_f32 v220, v104, v105
    v_cvt_pk_bf16_f32 v221, v106, v107
    v_cvt_pk_bf16_f32 v222, v108, v109
    v_cvt_pk_bf16_f32 v223, v110, v111
L_s2_tail7:
    s_waitcnt lgkmcnt(0)
    s_nop 0
    v_mfma_f32_32x32x16_bf16 v[64:79], v[144:147], v[216:219], v[64:79]
    v_mfma_f32_32x32x16_bf16 v[48:63], v[40:43], v[216:219], v[48:63]
    v_mfma_f32_32x32x16_bf16 v[64:79], v[144:147], v[220:223], v[64:79]
    v_mfma_f32_32x32x16_bf16 v[48:63], v[44:47], v[220:223], v[48:63]
    s_branch L_s2_p2_17
L_s2_tail6:
    s_waitcnt lgkmcnt(0)
    s_nop 0
    v_mfma_f32_32x32x16_bf16 v[64:79], v[144:147], v[148:151], v[64:79]
    v_mfma_f32_32x32x16_bf16 v[48:63], v[32:35], v[148:151], v[48:63]
    v_mfma_f32_32x32x16_bf16 v[64:79], v[144:147], v[152:155], v[64:79]
    v_mfma_f32_32x32x16_bf16 v[48:63], v[36:39], v[152:155], v[48:63]
    s_branch L_s2_p2_17
L_s2_tail5:
    s_waitcnt lgkmcnt(0)
    s_nop 0
    v_mfma_f32_32x32x16_bf16 v[64:79], v[144:147], v[216:219], v[64:79]
    v_mfma_f32_32x32x16_bf16 v[48:63], v[40:43], v[216:219], v[48:63]
    v_mfma_f32_32x32x16_bf16 v[64:79], v[144:147], v[220:223], v[64:79]
    v_mfma_f32_32x32x16_bf16 v[48:63], v[44:47], v[220:223], v[48:63]
    s_branch L_s2_p2_17
L_s2_tail4:
    s_waitcnt lgkmcnt(0)
    s_nop 0
    v_mfma_f32_32x32x16_bf16 v[64:79], v[144:147], v[148:151], v[64:79]
    v_mfma_f32_32x32x16_bf16 v[48:63], v[32:35], v[148:151], v[48:63]
    v_mfma_f32_32x32x16_bf16 v[64:79], v[144:147], v[152:155], v[64:79]
    v_mfma_f32_32x32x16_bf16 v[48:63], v[36:39], v[152:155], v[48:63]
    s_branch L_s2_p2_17
L_s2_tail3:
    s_waitcnt lgkmcnt(0)
    s_nop 0
    v_mfma_f32_32x32x16_bf16 v[64:79], v[144:147], v[216:219], v[64:79]
    v_mfma_f32_32x32x16_bf16 v[48:63], v[40:43], v[216:219], v[48:63]
    v_mfma_f32_32x32x16_bf16 v[64:79], v[144:147], v[220:223], v[64:79]
    v_mfma_f32_32x32x16_bf16 v[48:63], v[44:47], v[220:223], v[48:63]
    s_branch L_s2_p2_17
L_s2_tail2:
    s_waitcnt lgkmcnt(0)
    s_nop 0
    v_mfma_f32_32x32x16_bf16 v[64:79], v[144:147], v[148:151], v[64:79]
    v_mfma_f32_32x32x16_bf16 v[48:63], v[32:35], v[148:151], v[48:63]
    v_mfma_f32_32x32x16_bf16 v[64:79], v[144:147], v[152:155], v[64:79]
    v_mfma_f32_32x32x16_bf16 v[48:63], v[36:39], v[152:155], v[48:63]
    s_branch L_s2_p2_17
L_s2_tail1:
    s_waitcnt lgkmcnt(0)
    s_nop 0
    v_mfma_f32_32x32x16_bf16 v[64:79], v[144:147], v[216:219], v[64:79]
    v_mfma_f32_32x32x16_bf16 v[48:63], v[40:43], v[216:219], v[48:63]
    v_mfma_f32_32x32x16_bf16 v[64:79], v[144:147], v[220:223], v[64:79]
    v_mfma_f32_32x32x16_bf16 v[48:63], v[44:47], v[220:223], v[48:63]
    s_branch L_s2_p2_17
L_s2_tail0:
    s_waitcnt lgkmcnt(0)
    s_nop 0
    v_mfma_f32_32x32x16_bf16 v[64:79], v[144:147], v[148:151], v[64:79]
    v_mfma_f32_32x32x16_bf16 v[48:63], v[32:35], v[148:151], v[48:63]
    v_mfma_f32_32x32x16_bf16 v[64:79], v[144:147], v[152:155], v[64:79]
    v_mfma_f32_32x32x16_bf16 v[48:63], v[36:39], v[152:155], v[48:63]
L_s2_p2_17:
    s_nop 7
    s_nop 7
    v_cmp_ngt_f32 vcc, 0x5f800000, v64
    s_cmp_eq_u64 vcc, 0
    s_cbranch_scc1 L_att_fin
    v_mov_b32 v48, v232
    v_mov_b32 v49, v233
    v_mov_b32 v50, v234
    v_mov_b32 v51, v235
    v_mov_b32 v52, v236
    v_mov_b32 v53, v237
    v_mov_b32 v54, v238
    v_mov_b32 v55, v239
    v_mov_b32 v56, v240
    v_mov_b32 v57, v241
    v_mov_b32 v58, v242
    v_mov_b32 v59, v243
    v_mov_b32 v60, v244
    v_mov_b32 v61, v245
    v_mov_b32 v62, v246
    v_mov_b32 v63, v247
    v_mov_b32 v64, v156
    ds_read_b128 v[16:19], v209 offset:0
    ds_read_b128 v[20:23], v209 offset:1024
    v_fmaak_f32 v128, v200, v202, 0xf1000000
    v_fmaak_f32 v129, v200, v202, 0x71000000
    v_fmaak_f32 v130, v200, v202, 0x71c00000
    v_fmaak_f32 v131, v200, v202, 0x72200000
    v_fmaak_f32 v132, v200, v202, 0x72f00000
    v_fmaak_f32 v133, v200, v202, 0x73080000
    v_fmaak_f32 v134, v200, v202, 0x73180000
    v_fmaak_f32 v135, v200, v202, 0x73280000
    v_fmaak_f32 v136, v200, v202, 0x73780000
    v_fmaak_f32 v137, v200, v202, 0x73840000
    v_fmaak_f32 v138, v200, v202, 0x738c0000
    v_fmaak_f32 v139, v200, v202, 0x73940000
    v_fmaak_f32 v140, v200, v202, 0x73bc0000
    v_fmaak_f32 v141, v200, v202, 0x73c40000
    v_fmaak_f32 v142, v200, v202, 0x73cc0000
    v_fmaak_f32 v143, v200, v202, 0x73d40000
    v_min_f32 v128, 0, v128
    v_min_f32 v129, 0, v129
    v_min_f32 v130, 0, v130
    v_min_f32 v131, 0, v131
    v_min_f32 v132, 0, v132
    v_min_f32 v133, 0, v133
    v_min_f32 v134, 0, v134
    v_min_f32 v135, 0, v135
    v_min_f32 v136, 0, v136
    v_min_f32 v137, 0, v137
    v_min_f32 v138, 0, v138
    v_min_f32 v139, 0, v139
    v_min_f32 v140, 0, v140
    v_min_f32 v141, 0, v141
    v_min_f32 v142, 0, v142
    v_min_f32 v143, 0, v143
    ds_read_b128 v[24:27], v209 offset:2048
    ds_read_b128 v[28:31], v209 offset:3072
    s_waitcnt lgkmcnt(2)
    v_mfma_f32_32x32x16_bf16 v[80:95], v[16:19], v[8:11], 0
    v_mfma_f32_32x32x16_bf16 v[80:95], v[20:23], v[12:15], v[80:95]
    s_cmp_eq_u32 s57, 1
    s_cbranch_scc0 L_s2x_x1_22
    s_nop 7
    s_nop 3
    v_max3_f32 v204, v80, v81, v82
    v_max3_f32 v205, v83, v84, v85
    v_max3_f32 v204, v86, v87, v204
    v_max3_f32 v205, v88, v89, v205
    v_max3_f32 v204, v90, v91, v204
    v_max3_f32 v205, v92, v93, v205
    v_max3_f32 v204, v94, v95, v204
    s_branch L_s2x_p1_20
L_s2x_x1_22:
    ds_read_b128 v[16:19], v209 offset:4096
    ds_read_b128 v[20:23], v209 offset:5120
    s_waitcnt lgkmcnt(2)
    v_mfma_f32_32x32x16_bf16 v[96:111], v[24:27], v[8:11], 0
    v_mfma_f32_32x32x16_bf16 v[96:111], v[28:31], v[12:15], v[96:111]
    s_nop 4
    v_max3_f32 v204, v80, v81, v82
    v_max3_f32 v205, v83, v84, v85
    v_max3_f32 v204, v86, v87, v204
    v_max3_f32 v205, v88, v89, v205
    v_max3_f32 v204, v90, v91, v204
    v_max3_f32 v205, v92, v93, v205
    v_max3_f32 v204, v94, v95, v204
    s_cmp_eq_u32 s57, 2
    s_cbranch_scc0 L_s2x_x1_23
    s_nop 7
    s_nop 3
    v_max3_f32 v204, v96, v97, v204
    v_max3_f32 v205, v98, v99, v205
    v_max3_f32 v204, v100, v101, v204
    v_max3_f32 v205, v102, v103, v205
    v_max3_f32 v204, v104, v105, v204
    v_max3_f32 v205, v106, v107, v205
    v_max3_f32 v204, v108, v109, v204
    v_max3_f32 v205, v110, v111, v205
    s_branch L_s2x_p1_20
L_s2x_x1_23:
    ds_read_b128 v[24:27], v209 offset:6144
    ds_read_b128 v[28:31], v209 offset:7168
    s_waitcnt lgkmcnt(2)
    v_mfma_f32_32x32x16_bf16 v[80:95], v[16:19], v[8:11], 0
    v_mfma_f32_32x32x16_bf16 v[80:95], v[20:23], v[12:15], v[80:95]
    s_nop 4
    v_max3_f32 v204, v96, v97, v204
    v_max3_f32 v205, v98, v99, v205
    v_max3_f32 v204, v100, v101, v204
    v_max3_f32 v205, v102, v103, v205
    v_max3_f32 v204, v104, v105, v204
    v_max3_f32 v205, v106, v107, v205
    v_max3_f32 v204, v108, v109, v204
    v_max3_f32 v205, v110, v111, v205
    s_cmp_eq_u32 s57, 3
    s_cbranch_scc0 L_s2x_x1_24
    s_nop 7
    s_nop 3
    v_max3_f32 v204, v80, v81, v204
    v_max3_f32 v205, v82, v83, v205
    v_max3_f32 v204, v84, v85, v204
    v_max3_f32 v205, v86, v87, v205
    v_max3_f32 v204, v88, v89, v204
    v_max3_f32 v205, v90, v91, v205
    v_max3_f32 v204, v92, v93, v204
    v_max3_f32 v205, v94, v95, v205
    s_branch L_s2x_p1_20
L_s2x_x1_24:
    ds_read_b128 v[16:19], v210 offset:0
    ds_read_b128 v[20:23], v210 offset:1024
    s_waitcnt lgkmcnt(2)
    v_mfma_f32_32x32x16_bf16 v[96:111], v[24:27], v[8:11], 0
    v_mfma_f32_32x32x16_bf16 v[96:111], v[28:31], v[12:15], v[96:111]
    s_nop 4
    v_max3_f32 v204, v80, v81, v204
    v_max3_f32 v205, v82, v83, v205
    v_max3_f32 v204, v84, v85, v204
    v_max3_f32 v205, v86, v87, v205
    v_max3_f32 v204, v88, v89, v204
    v_max3_f32 v205, v90, v91, v205
    v_max3_f32 v204, v92, v93, v204
    v_max3_f32 v205, v94, v95, v205
    s_cmp_eq_u32 s57, 4
    s_cbranch_scc0 L_s2x_x1_25
    s_nop 7
    s_nop 3
    v_max3_f32 v204, v96, v97, v204
    v_max3_f32 v205, v98, v99, v205
    v_max3_f32 v204, v100, v101, v204
    v_max3_f32 v205, v102, v103, v205
    v_max3_f32 v204, v104, v105, v204
    v_max3_f32 v205, v106, v107, v205
    v_max3_f32 v204, v108, v109, v204
    v_max3_f32 v205, v110, v111, v205
    s_branch L_s2x_p1_20
L_s2x_x1_25:
    ds_read_b128 v[24:27], v210 offset:2048
    ds_read_b128 v[28:31], v210 offset:3072
    s_waitcnt lgkmcnt(2)
    v_mfma_f32_32x32x16_bf16 v[80:95], v[16:19], v[8:11], v[128:143]
    v_mfma_f32_32x32x16_bf16 v[80:95], v[20:23], v[12:15], v[80:95]
    s_nop 4
    v_max3_f32 v204, v96, v97, v204
    v_max3_f32 v205, v98, v99, v205
    v_max3_f32 v204, v100, v101, v204
    v_max3_f32 v205, v102, v103, v205
    v_max3_f32 v204, v104, v105, v204
    v_max3_f32 v205, v106, v107, v205
    v_max3_f32 v204, v108, v109, v204
    v_max3_f32 v205, v110, v111, v205
    s_cmp_eq_u32 s57, 5
    s_cbranch_scc0 L_s2x_x1_26
    s_nop 7
    s_nop 3
    v_max3_f32 v204, v80, v81, v204
    v_max3_f32 v205, v82, v83, v205
    v_max3_f32 v204, v84, v85, v204
    v_max3_f32 v205, v86, v87, v205
    v_max3_f32 v204, v88, v89, v204
    v_max3_f32 v205, v90, v91, v205
    v_max3_f32 v204, v92, v93, v204
    v_max3_f32 v205, v94, v95, v205
    s_branch L_s2x_p1_20
L_s2x_x1_26:
    ds_read_b128 v[16:19], v210 offset:4096
    ds_read_b128 v[20:23], v210 offset:5120
    s_waitcnt lgkmcnt(2)
    v_mfma_f32_32x32x16_bf16 v[96:111], v[24:27], v[8:11], 0
    v_mfma_f32_32x32x16_bf16 v[96:111], v[28:31], v[12:15], v[96:111]
    s_nop 4
    v_max3_f32 v204, v80, v81, v204
    v_max3_f32 v205, v82, v83, v205
    v_max3_f32 v204, v84, v85, v204
    v_max3_f32 v205, v86, v87, v205
    v_max3_f32 v204, v88, v89, v204
    v_max3_f32 v205, v90, v91, v205
    v_max3_f32 v204, v92, v93, v204
    v_max3_f32 v205, v94, v95, v205
    s_cmp_eq_u32 s57, 6
    s_cbranch_scc0 L_s2x_x1_27
    s_nop 7
    s_nop 3
    v_max3_f32 v204, v96, v97, v204
    v_max3_f32 v205, v98, v99, v205
    v_max3_f32 v204, v100, v101, v204
    v_max3_f32 v205, v102, v103, v205
    v_max3_f32 v204, v104, v105, v204
    v_max3_f32 v205, v106, v107, v205
    v_max3_f32 v204, v108, v109, v204
    v_max3_f32 v205, v110, v111, v205
    s_branch L_s2x_p1_20
L_s2x_x1_27:
    ds_read_b128 v[24:27], v210 offset:6144
    ds_read_b128 v[28:31], v210 offset:7168
    s_waitcnt lgkmcnt(2)
    v_mfma_f32_32x32x16_bf16 v[80:95], v[16:19], v[8:11], 0
    v_mfma_f32_32x32x16_bf16 v[80:95], v[20:23], v[12:15], v[80:95]
    s_nop 4
    v_max3_f32 v204, v96, v97, v204
    v_max3_f32 v205, v98, v99, v205
    v_max3_f32 v204, v100, v101, v204
    v_max3_f32 v205, v102, v103, v205
    v_max3_f32 v204, v104, v105, v204
    v_max3_f32 v205, v106, v107, v205
    v_max3_f32 v204, v108, v109, v204
    v_max3_f32 v205, v110, v111, v205
    s_cmp_eq_u32 s57, 7
    s_cbranch_scc0 L_s2x_x1_28
    s_nop 7
    s_nop 3
    v_max3_f32 v204, v80, v81, v204
    v_max3_f32 v205, v82, v83, v205
    v_max3_f32 v204, v84, v85, v204
    v_max3_f32 v205, v86, v87, v205
    v_max3_f32 v204, v88, v89, v204
    v_max3_f32 v205, v90, v91, v205
    v_max3_f32 v204, v92, v93, v204
    v_max3_f32 v205, v94, v95, v205
    s_branch L_s2x_p1_20
L_s2x_x1_28:
    s_waitcnt lgkmcnt(0)
    v_mfma_f32_32x32x16_bf16 v[96:111], v[24:27], v[8:11], 0
    v_mfma_f32_32x32x16_bf16 v[96:111], v[28:31], v[12:15], v[96:111]
    s_nop 4
    v_max3_f32 v204, v80, v81, v204
    v_max3_f32 v205, v82, v83, v205
    v_max3_f32 v204, v84, v85, v204
    v_max3_f32 v205, v86, v87, v205
    v_max3_f32 v204, v88, v89, v204
    v_max3_f32 v205, v90, v91, v205
    v_max3_f32 v204, v92, v93, v204
    v_max3_f32 v205, v94, v95, v205
    s_nop 7
    s_nop 3
    v_max3_f32 v204, v96, v97, v204
    v_max3_f32 v205, v98, v99, v205
    v_max3_f32 v204, v100, v101, v204
    v_max3_f32 v205, v102, v103, v205
    v_max3_f32 v204, v104, v105, v204
    v_max3_f32 v205, v106, v107, v205
    v_max3_f32 v204, v108, v109, v204
    v_max3_f32 v205, v110, v111, v205
L_s2x_p1_20:
    s_waitcnt lgkmcnt(0)
    ds_read_b128 v[16:19], v209 offset:0
    ds_read_b128 v[20:23], v209 offset:1024
    ds_read_b128 v[32:35], v209 offset:8192
    ds_read_b128 v[36:39], v209 offset:9216
    v_max_f32 v204, v204, v205
    v_mov_b32 v205, v204
    s_nop 1
    v_permlane32_swap_b32 v205, v204
    v_max_f32 v204, v204, v205
    v_max_f32 v204, v204, v192
    v_sub_f32 v206, v192, v204
    v_exp_f32 v206, v206
    v_mov_b32 v192, v204
    v_mul_f32 v48, v48, v206
    v_mul_f32 v49, v49, v206
    v_mul_f32 v50, v50, v206
    v_mul_f32 v51, v51, v206
    v_mul_f32 v52, v52, v206
    v_mul_f32 v53, v53, v206
    v_mul_f32 v54, v54, v206
    v_mul_f32 v55, v55, v206
    v_mul_f32 v56, v56, v206
    v_mul_f32 v57, v57, v206
    v_mul_f32 v58, v58, v206
    v_mul_f32 v59, v59, v206
    v_mul_f32 v60, v60, v206
    v_mul_f32 v61, v61, v206
    v_mul_f32 v62, v62, v206
    v_mul_f32 v63, v63, v206
    v_mul_f32 v64, v64, v206
    v_sub_f32 v112, 0, v204
    v_sub_f32 v113, 0, v204
    v_sub_f32 v114, 0, v204
    v_sub_f32 v115, 0, v204
    v_sub_f32 v116, 0, v204
    v_sub_f32 v117, 0, v204
    v_sub_f32 v118, 0, v204
    v_sub_f32 v119, 0, v204
    v_sub_f32 v120, 0, v204
    v_sub_f32 v121, 0, v204
    v_sub_f32 v122, 0, v204
    v_sub_f32 v123, 0, v204
    v_sub_f32 v124, 0, v204
    v_sub_f32 v125, 0, v204
    v_sub_f32 v126, 0, v204
    v_sub_f32 v127, 0, v204
    v_sub_f32 v128, v128, v204
    v_sub_f32 v129, v129, v204
    v_sub_f32 v130, v130, v204
    v_sub_f32 v131, v131, v204
    v_sub_f32 v132, v132, v204
    v_sub_f32 v133, v133, v204
    v_sub_f32 v134, v134, v204
    v_sub_f32 v135, v135, v204
    v_sub_f32 v136, v136, v204
    v_sub_f32 v137, v137, v204
    v_sub_f32 v138, v138, v204
    v_sub_f32 v139, v139, v204
    v_sub_f32 v140, v140, v204
    v_sub_f32 v141, v141, v204
    v_sub_f32 v142, v142, v204
    v_sub_f32 v143, v143, v204
    s_waitcnt lgkmcnt(2)
    s_nop 0
    v_mfma_f32_32x32x16_bf16 v[80:95], v[16:19], v[8:11], v[112:127]
    v_mfma_f32_32x32x16_bf16 v[80:95], v[20:23], v[12:15], v[80:95]
    ds_read_b128 v[24:27], v209 offset:2048
    ds_read_b128 v[28:31], v209 offset:3072
    s_waitcnt lgkmcnt(0)
    v_mfma_f32_32x32x16_bf16 v[96:111], v[24:27], v[8:11], v[112:127]
    v_mfma_f32_32x32x16_bf16 v[96:111], v[28:31], v[12:15], v[96:111]
    s_nop 7
    ds_read_b128 v[16:19], v209 offset:4096
    ds_read_b128 v[20:23], v209 offset:5120
    v_exp_f32 v80, v80
    v_exp_f32 v81, v81
    v_exp_f32 v82, v82
    v_exp_f32 v83, v83
    v_exp_f32 v84, v84
    v_exp_f32 v85, v85
    v_exp_f32 v86, v86
    v_exp_f32 v87, v87
    v_exp_f32 v88, v88
    v_exp_f32 v89, v89
    v_exp_f32 v90, v90
    v_exp_f32 v91, v91
    v_exp_f32 v92, v92
    v_exp_f32 v93, v93
    v_exp_f32 v94, v94
    v_exp_f32 v95, v95
    v_cvt_pk_bf16_f32 v148, v80, v81
    v_cvt_pk_bf16_f32 v149, v82, v83
    v_cvt_pk_bf16_f32 v150, v84, v85
    v_cvt_pk_bf16_f32 v151, v86, v87
    v_cvt_pk_bf16_f32 v152, v88, v89
    v_cvt_pk_bf16_f32 v153, v90, v91
    v_cvt_pk_bf16_f32 v154, v92, v93
    v_cvt_pk_bf16_f32 v155, v94, v95
    s_cmp_eq_u32 s57, 1
    s_cbranch_scc1 L_s2x_tail0
    s_waitcnt lgkmcnt(0)
    v_mfma_f32_32x32x16_bf16 v[64:79], v[144:147], v[148:151], v[64:79]
    v_exp_f32 v96, v96
    v_exp_f32 v97, v97
    v_exp_f32 v98, v98
    v_mfma_f32_32x32x16_bf16 v[48:63], v[32:35], v[148:151], v[48:63]
    v_exp_f32 v99, v99
    v_exp_f32 v100, v100
    v_exp_f32 v101, v101
    v_mfma_f32_32x32x16_bf16 v[64:79], v[144:147], v[152:155], v[64:79]
    v_exp_f32 v102, v102
    v_exp_f32 v103, v103
    v_exp_f32 v104, v104
    v_mfma_f32_32x32x16_bf16 v[48:63], v[36:39], v[152:155], v[48:63]
    v_exp_f32 v105, v105
    v_exp_f32 v106, v106
    v_exp_f32 v107, v107
    ds_read_b128 v[40:43], v209 offset:10240
    ds_read_b128 v[44:47], v209 offset:11264
    ds_read_b128 v[24:27], v209 offset:6144
    ds_read_b128 v[28:31], v209 offset:7168
    v_mfma_f32_32x32x16_bf16 v[80:95], v[16:19], v[8:11], v[112:127]
    v_exp_f32 v108, v108
    v_exp_f32 v109, v109
    v_exp_f32 v110, v110
    v_mfma_f32_32x32x16_bf16 v[80:95], v[20:23], v[12:15], v[80:95]
    v_exp_f32 v111, v111
    v_cvt_pk_bf16_f32 v216, v96, v97
    v_cvt_pk_bf16_f32 v217, v98, v99
    v_cvt_pk_bf16_f32 v218, v100, v101
    v_cvt_pk_bf16_f32 v219, v102, v103
    v_cvt_pk_bf16_f32 v220, v104, v105
    v_cvt_pk_bf16_f32 v221, v106, v107
    v_cvt_pk_bf16_f32 v222, v108, v109
    v_cvt_pk_bf16_f32 v223, v110, v111
    s_cmp_eq_u32 s57, 2
    s_cbranch_scc1 L_s2x_tail1
    s_waitcnt lgkmcnt(0)
    v_mfma_f32_32x32x16_bf16 v[64:79], v[144:147], v[216:219], v[64:79]
    v_exp_f32 v80, v80
    v_exp_f32 v81, v81
    v_exp_f32 v82, v82
    v_mfma_f32_32x32x16_bf16 v[48:63], v[40:43], v[216:219], v[48:63]
    v_exp_f32 v83, v83
    v_exp_f32 v84, v84
    v_exp_f32 v85, v85
    v_mfma_f32_32x32x16_bf16 v[64:79], v[144:147], v[220:223], v[64:79]
    v_exp_f32 v86, v86
    v_exp_f32 v87, v87
    v_exp_f32 v88, v88
    v_mfma_f32_32x32x16_bf16 v[48:63], v[44:47], v[220:223], v[48:63]
    v_exp_f32 v89, v89
    v_exp_f32 v90, v90
    v_exp_f32 v91, v91
    ds_read_b128 v[32:35], v209 offset:12288
    ds_read_b128 v[36:39], v209 offset:13312
    ds_read_b128 v[16:19], v210 offset:0
    ds_read_b128 v[20:23], v210 offset:1024
    v_mfma_f32_32x32x16_bf16 v[96:111], v[24:27], v[8:11], v[112:127]
    v_exp_f32 v92, v92
    v_exp_f32 v93, v93
    v_exp_f32 v94, v94
    v_mfma_f32_32x32x16_bf16 v[96:111], v[28:31], v[12:15], v[96:111]
    v_exp_f32 v95, v95
    v_cvt_pk_bf16_f32 v148, v80, v81
    v_cvt_pk_bf16_f32 v149, v82, v83
    v_cvt_pk_bf16_f32 v150, v84, v85
    v_cvt_pk_bf16_f32 v151, v86, v87
    v_cvt_pk_bf16_f32 v152, v88, v89
    v_cvt_pk_bf16_f32 v153, v90, v91
    v_cvt_pk_bf16_f32 v154, v92, v93
    v_cvt_pk_bf16_f32 v155, v94, v95
    s_cmp_eq_u32 s57, 3
    s_cbranch_scc1 L_s2x_tail2
    s_waitcnt lgkmcnt(0)
    v_mfma_f32_32x32x16_bf16 v[64:79], v[144:147], v[148:151], v[64:79]
    v_exp_f32 v96, v96
    v_exp_f32 v97, v97
    v_exp_f32 v98, v98
    v_mfma_f32_32x32x16_bf16 v[48:63], v[32:35], v[148:151], v[48:63]
    v_exp_f32 v99, v99
    v_exp_f32 v100, v100
    v_exp_f32 v101, v101
    v_mfma_f32_32x32x16_bf16 v[64:79], v[144:147], v[152:155], v[64:79]
    v_exp_f32 v102, v102
    v_exp_f32 v103, v103
    v_exp_f32 v104, v104
    v_mfma_f32_32x32x16_bf16 v[48:63], v[36:39], v[152:155], v[48:63]
    v_exp_f32 v105, v105
    v_exp_f32 v106, v106
    v_exp_f32 v107, v107
    ds_read_b128 v[40:43], v209 offset:14336
    ds_read_b128 v[44:47], v209 offset:15360
    ds_read_b128 v[24:27], v210 offset:2048
    ds_read_b128 v[28:31], v210 offset:3072
    v_mfma_f32_32x32x16_bf16 v[80:95], v[16:19], v[8:11], v[128:143]
    v_exp_f32 v108, v108
    v_exp_f32 v109, v109
    v_exp_f32 v110, v110
    v_mfma_f32_32x32x16_bf16 v[80:95], v[20:23], v[12:15], v[80:95]
    v_exp_f32 v111, v111
    v_cvt_pk_bf16_f32 v216, v96, v97
    v_cvt_pk_bf16_f32 v217, v98, v99
    v_cvt_pk_bf16_f32 v218, v100, v101
    v_cvt_pk_bf16_f32 v219, v102, v103
    v_cvt_pk_bf16_f32 v220, v104, v105
    v_cvt_pk_bf16_f32 v221, v106, v107
    v_cvt_pk_bf16_f32 v222, v108, v109
    v_cvt_pk_bf16_f32 v223, v110, v111
    s_cmp_eq_u32 s57, 4
    s_cbranch_scc1 L_s2x_tail3
    s_waitcnt lgkmcnt(0)
    v_mfma_f32_32x32x16_bf16 v[64:79], v[144:147], v[216:219], v[64:79]
    v_exp_f32 v80, v80
    v_exp_f32 v81, v81
    v_exp_f32 v82, v82
    v_mfma_f32_32x32x16_bf16 v[48:63], v[40:43], v[216:219], v[48:63]
    v_exp_f32 v83, v83
    v_exp_f32 v84, v84
    v_exp_f32 v85, v85
    v_mfma_f32_32x32x16_bf16 v[64:79], v[144:147], v[220:223], v[64:79]
    v_exp_f32 v86, v86
    v_exp_f32 v87, v87
    v_exp_f32 v88, v88
    v_mfma_f32_32x32x16_bf16 v[48:63], v[44:47], v[220:223], v[48:63]
    v_exp_f32 v89, v89
    v_exp_f32 v90, v90
    v_exp_f32 v91, v91
    ds_read_b128 v[32:35], v210 offset:8192
    ds_read_b128 v[36:39], v210 offset:9216
    ds_read_b128 v[16:19], v210 offset:4096
    ds_read_b128 v[20:23], v210 offset:5120
    v_mfma_f32_32x32x16_bf16 v[96:111], v[24:27], v[8:11], v[112:127]
    v_exp_f32 v92, v92
    v_exp_f32 v93, v93
    v_exp_f32 v94, v94
    v_mfma_f32_32x32x16_bf16 v[96:111], v[28:31], v[12:15], v[96:111]
    v_exp_f32 v95, v95
    v_cvt_pk_bf16_f32 v148, v80, v81
    v_cvt_pk_bf16_f32 v149, v82, v83
    v_cvt_pk_bf16_f32 v150, v84, v85
    v_cvt_pk_bf16_f32 v151, v86, v87
    v_cvt_pk_bf16_f32 v152, v88, v89
    v_cvt_pk_bf16_f32 v153, v90, v91
    v_cvt_pk_bf16_f32 v154, v92, v93
    v_cvt_pk_bf16_f32 v155, v94, v95
    s_cmp_eq_u32 s57, 5
    s_cbranch_scc1 L_s2x_tail4
    s_waitcnt lgkmcnt(0)
    v_mfma_f32_32x32x16_bf16 v[64:79], v[144:147], v[148:151], v[64:79]
    v_exp_f32 v96, v96
    v_exp_f32 v97, v97
    v_exp_f32 v98, v98
    v_mfma_f32_32x32x16_bf16 v[48:63], v[32:35], v[148:151], v[48:63]
    v_exp_f32 v99, v99
    v_exp_f32 v100, v100
    v_exp_f32 v101, v101
    v_mfma_f32_32x32x16_bf16 v[64:79], v[144:147], v[152:155], v[64:79]
    v_exp_f32 v102, v102
    v_exp_f32 v103, v103
    v_exp_f32 v104, v104
    v_mfma_f32_32x32x16_bf16 v[48:63], v[36:39], v[152:155], v[48:63]
    v_exp_f32 v105, v105
    v_exp_f32 v106, v106
    v_exp_f32 v107, v107
    ds_read_b128 v[40:43], v210 offset:10240
    ds_read_b128 v[44:47], v210 offset:11264
    ds_read_b128 v[24:27], v210 offset:6144
    ds_read_b128 v[28:31], v210 offset:7168
    v_mfma_f32_32x32x16_bf16 v[80:95], v[16:19], v[8:11], v[112:127]
    v_exp_f32 v108, v108
    v_exp_f32 v109, v109
    v_exp_f32 v110, v110
    v_mfma_f32_32x32x16_bf16 v[80:95], v[20:23], v[12:15], v[80:95]
    v_exp_f32 v111, v111
    v_cvt_pk_bf16_f32 v216, v96, v97
    v_cvt_pk_bf16_f32 v217, v98, v99
    v_cvt_pk_bf16_f32 v218, v100, v101
    v_cvt_pk_bf16_f32 v219, v102, v103
    v_cvt_pk_bf16_f32 v220, v104, v105
    v_cvt_pk_bf16_f32 v221, v106, v107
    v_cvt_pk_bf16_f32 v222, v108, v109
    v_cvt_pk_bf16_f32 v223, v110, v111
    s_cmp_eq_u32 s57, 6
    s_cbranch_scc1 L_s2x_tail5
    s_waitcnt lgkmcnt(0)
    v_mfma_f32_32x32x16_bf16 v[64:79], v[144:147], v[216:219], v[64:79]
    v_exp_f32 v80, v80
    v_exp_f32 v81, v81
    v_exp_f32 v82, v82
    v_mfma_f32_32x32x16_bf16 v[48:63], v[40:43], v[216:219], v[48:63]
    v_exp_f32 v83, v83
    v_exp_f32 v84, v84
    v_exp_f32 v85, v85
    v_mfma_f32_32x32x16_bf16 v[64:79], v[144:147], v[220:223], v[64:79]
    v_exp_f32 v86, v86
    v_exp_f32 v87, v87
    v_exp_f32 v88, v88
    v_mfma_f32_32x32x16_bf16 v[48:63], v[44:47], v[220:223], v[48:63]
    v_exp_f32 v89, v89
    v_exp_f32 v90, v90
    v_exp_f32 v91, v91
    ds_read_b128 v[32:35], v210 offset:12288
    ds_read_b128 v[36:39], v210 offset:13312
    v_mfma_f32_32x32x16_bf16 v[96:111], v[24:27], v[8:11], v[112:127]
    v_exp_f32 v92, v92
    v_exp_f32 v93, v93
    v_exp_f32 v94, v94
    v_mfma_f32_32x32x16_bf16 v[96:111], v[28:31], v[12:15], v[96:111]
    v_exp_f32 v95, v95
    v_cvt_pk_bf16_f32 v148, v80, v81
    v_cvt_pk_bf16_f32 v149, v82, v83
    v_cvt_pk_bf16_f32 v150, v84, v85
    v_cvt_pk_bf16_f32 v151, v86, v87
    v_cvt_pk_bf16_f32 v152, v88, v89
    v_cvt_pk_bf16_f32 v153, v90, v91
    v_cvt_pk_bf16_f32 v154, v92, v93
    v_cvt_pk_bf16_f32 v155, v94, v95
    s_cmp_eq_u32 s57, 7
    s_cbranch_scc1 L_s2x_tail6
    s_waitcnt lgkmcnt(0)
    v_mfma_f32_32x32x16_bf16 v[64:79], v[144:147], v[148:151], v[64:79]
    v_exp_f32 v96, v96
    v_exp_f32 v97, v97
    v_exp_f32 v98, v98
    v_mfma_f32_32x32x16_bf16 v[48:63], v[32:35], v[148:151], v[48:63]
    v_exp_f32 v99, v99
    v_exp_f32 v100, v100
    v_exp_f32 v101, v101
    v_mfma_f32_32x32x16_bf16 v[64:79], v[144:147], v[152:155], v[64:79]
    v_exp_f32 v102, v102
    v_exp_f32 v103, v103
    v_exp_f32 v104, v104
    v_mfma_f32_32x32x16_bf16 v[48:63], v[36:39], v[152:155], v[48:63]
    v_exp_f32 v105, v105
    v_exp_f32 v106, v106
    v_exp_f32 v107, v107
    v_exp_f32 v108, v108
    v_exp_f32 v109, v109
    v_exp_f32 v110, v110
    v_exp_f32 v111, v111
    ds_read_b128 v[40:43], v210 offset:14336
    ds_read_b128 v[44:47], v210 offset:15360
    v_cvt_pk_bf16_f32 v216, v96, v97
    v_cvt_pk_bf16_f32 v217, v98, v99
    v_cvt_pk_bf16_f32 v218, v100, v101
    v_cvt_pk_bf16_f32 v219, v102, v103
    v_cvt_pk_bf16_f32 v220, v104, v105
    v_cvt_pk_bf16_f32 v221, v106, v107
    v_cvt_pk_bf16_f32 v222, v108, v109
    v_cvt_pk_bf16_f32 v223, v110, v111
L_s2x_tail7:
    s_waitcnt lgkmcnt(0)
    s_nop 0
    v_mfma_f32_32x32x16_bf16 v[64:79], v[144:147], v[216:219], v[64:79]
    v_mfma_f32_32x32x16_bf16 v[48:63], v[40:43], v[216:219], v[48:63]
    v_mfma_f32_32x32x16_bf16 v[64:79], v[144:147], v[220:223], v[64:79]
    v_mfma_f32_32x32x16_bf16 v[48:63], v[44:47], v[220:223], v[48:63]
    s_branch L_s2x_p2_21
L_s2x_tail6:
    s_waitcnt lgkmcnt(0)
    s_nop 0
    v_mfma_f32_32x32x16_bf16 v[64:79], v[144:147], v[148:151], v[64:79]
    v_mfma_f32_32x32x16_bf16 v[48:63], v[32:35], v[148:151], v[48:63]
    v_mfma_f32_32x32x16_bf16 v[64:79], v[144:147], v[152:155], v[64:79]
    v_mfma_f32_32x32x16_bf16 v[48:63], v[36:39], v[152:155], v[48:63]
    s_branch L_s2x_p2_21
L_s2x_tail5:
    s_waitcnt lgkmcnt(0)
    s_nop 0
    v_mfma_f32_32x32x16_bf16 v[64:79], v[144:147], v[216:219], v[64:79]
    v_mfma_f32_32x32x16_bf16 v[48:63], v[40:43], v[216:219], v[48:63]
    v_mfma_f32_32x32x16_bf16 v[64:79], v[144:147], v[220:223], v[64:79]
    v_mfma_f32_32x32x16_bf16 v[48:63], v[44:47], v[220:223], v[48:63]
    s_branch L_s2x_p2_21
L_s2x_tail4:
    s_waitcnt lgkmcnt(0)
    s_nop 0
    v_mfma_f32_32x32x16_bf16 v[64:79], v[144:147], v[148:151], v[64:79]
    v_mfma_f32_32x32x16_bf16 v[48:63], v[32:35], v[148:151], v[48:63]
    v_mfma_f32_32x32x16_bf16 v[64:79], v[144:147], v[152:155], v[64:79]
    v_mfma_f32_32x32x16_bf16 v[48:63], v[36:39], v[152:155], v[48:63]
    s_branch L_s2x_p2_21
L_s2x_tail3:
    s_waitcnt lgkmcnt(0)
    s_nop 0
    v_mfma_f32_32x32x16_bf16 v[64:79], v[144:147], v[216:219], v[64:79]
    v_mfma_f32_32x32x16_bf16 v[48:63], v[40:43], v[216:219], v[48:63]
    v_mfma_f32_32x32x16_bf16 v[64:79], v[144:147], v[220:223], v[64:79]
    v_mfma_f32_32x32x16_bf16 v[48:63], v[44:47], v[220:223], v[48:63]
    s_branch L_s2x_p2_21
L_s2x_tail2:
    s_waitcnt lgkmcnt(0)
    s_nop 0
    v_mfma_f32_32x32x16_bf16 v[64:79], v[144:147], v[148:151], v[64:79]
    v_mfma_f32_32x32x16_bf16 v[48:63], v[32:35], v[148:151], v[48:63]
    v_mfma_f32_32x32x16_bf16 v[64:79], v[144:147], v[152:155], v[64:79]
    v_mfma_f32_32x32x16_bf16 v[48:63], v[36:39], v[152:155], v[48:63]
    s_branch L_s2x_p2_21
L_s2x_tail1:
    s_waitcnt lgkmcnt(0)
    s_nop 0
    v_mfma_f32_32x32x16_bf16 v[64:79], v[144:147], v[216:219], v[64:79]
    v_mfma_f32_32x32x16_bf16 v[48:63], v[40:43], v[216:219], v[48:63]
    v_mfma_f32_32x32x16_bf16 v[64:79], v[144:147], v[220:223], v[64:79]
    v_mfma_f32_32x32x16_bf16 v[48:63], v[44:47], v[220:223], v[48:63]
    s_branch L_s2x_p2_21
L_s2x_tail0:
    s_waitcnt lgkmcnt(0)
    s_nop 0
    v_mfma_f32_32x32x16_bf16 v[64:79], v[144:147], v[148:151], v[64:79]
    v_mfma_f32_32x32x16_bf16 v[48:63], v[32:35], v[148:151], v[48:63]
    v_mfma_f32_32x32x16_bf16 v[64:79], v[144:147], v[152:155], v[64:79]
    v_mfma_f32_32x32x16_bf16 v[48:63], v[36:39], v[152:155], v[48:63]
L_s2x_p2_21:
    s_branch L_att_fin
L_att_rb0:
    s_cmp_lt_u32 s28, 4
    s_cbranch_scc1 L_side_32_c
    s_mov_b32 m0, s62
    s_add_u32 s62, s62, 1024
    buffer_load_dwordx4 v212, s[20:23], s63 offen nt lds
    s_add_u32 s63, s63, 57344
    s_mov_b32 m0, s62
    s_add_u32 s62, s62, 1024
    buffer_load_dwordx4 v212, s[20:23], s63 offen nt lds
    s_add_u32 s63, s63, 57344
    s_branch L_side_32_j
L_side_32_c:
    global_load_dwordx2 v[248:249], v231, s[60:61]
    global_load_dwordx2 v[250:251], v231, s[60:61] offset:16
    global_load_dwordx2 v[252:253], v231, s[60:61] offset:32
    global_load_dwordx2 v[254:255], v231, s[60:61] offset:48
L_side_32_j:
    s_cmp_lt_u32 s28, 4
    s_cbranch_scc1 L_side_33_c
    s_mov_b32 m0, s62
    s_add_u32 s62, s62, 1024
    buffer_load_dwordx4 v212, s[20:23], s63 offen nt lds
    s_add_u32 s63, s63, 57344
    s_mov_b32 m0, s62
    s_add_u32 s62, s62, 1024
    buffer_load_dwordx4 v212, s[20:23], s63 offen nt lds
    s_add_u32 s63, s63, 57344
    s_branch L_side_33_j
L_side_33_c:
L_side_33_j:
    s_cmp_lt_u32 s28, 4
    s_cbranch_scc1 L_side_34_c
    s_mov_b32 m0, s62
    s_add_u32 s62, s62, 1024
    buffer_load_dwordx4 v212, s[20:23], s63 offen nt lds
    s_add_u32 s63, s63, 57344
    s_mov_b32 m0, s62
    s_add_u32 s62, s62, 1024
    buffer_load_dwordx4 v212, s[20:23], s63 offen nt lds
    s_add_u32 s63, s63, 57344
    global_load_dword v255, v211, s[50:51]
    s_branch L_side_34_j
L_side_34_c:
L_side_34_j:
    s_cmp_lt_u32 s28, 4
    s_cbranch_scc1 L_side_35_c
    s_mov_b32 m0, s62
    s_add_u32 s62, s62, 1024
    buffer_load_dwordx4 v212, s[20:23], s63 offen nt lds
    s_add_u32 s63, s63, 57344
    s_mov_b32 m0, s62
    s_add_u32 s62, s62, 1024
    buffer_load_dwordx4 v212, s[20:23], s63 offen nt lds
    s_add_u32 s63, s63, 57344
    s_branch L_side_35_j
L_side_35_c:
L_side_35_j:
L_att_fin:
    s_nop 7
    s_nop 7
    v_rcp_f32 v204, v64
    s_lshl_b32 s30, s26, 2
    s_add_u32 s30, s30, s55
    s_lshl_b32 s30, s30, 5
    s_lshl_b32 s31, s27, 1
    s_add_u32 s30, s30, s31
    s_add_u32 s30, s30, s56
    s_lshl_b32 s30, s30, 11
    s_add_u32 s30, s30, 8388608
    v_lshlrev_b32 v2, 4, v1
    s_nop 3
    v_mul_f32 v48, v48, v204
    v_mul_f32 v49, v49, v204
    v_mul_f32 v50, v50, v204
    v_mul_f32 v51, v51, v204
    v_mul_f32 v52, v52, v204
    v_mul_f32 v53, v53, v204
    v_mul_f32 v54, v54, v204
    v_mul_f32 v55, v55, v204
    v_mul_f32 v56, v56, v204
    v_mul_f32 v57, v57, v204
    v_mul_f32 v58, v58, v204
    v_mul_f32 v59, v59, v204
    v_mul_f32 v60, v60, v204
    v_mul_f32 v61, v61, v204
    v_mul_f32 v62, v62, v204
    v_mul_f32 v63, v63, v204
    v_cvt_pk_bf16_f32 v48, v48, v49
    v_cvt_pk_bf16_f32 v49, v50, v51
    v_cvt_pk_bf16_f32 v50, v52, v53
    v_cvt_pk_bf16_f32 v51, v54, v55
    v_cvt_pk_bf16_f32 v52, v56, v57
    v_cvt_pk_bf16_f32 v53, v58, v59
    v_cvt_pk_bf16_f32 v54, v60, v61
    v_cvt_pk_bf16_f32 v55, v62, v63
    s_lshl_b32 s31, s29, 11
    s_add_u32 s31, s31, 73728
    v_add_u32 v3, s31, v2
    s_cmp_lt_u32 s28, 4
    s_cbranch_scc1 L_oh_c
    ds_write_b128 v3, v[48:51]
    ds_write_b128 v3, v[52:55] offset:1024
    s_waitcnt vmcnt(0) lgkmcnt(0)
    s_barrier
    s_branch L_oh_j
L_oh_c:
    buffer_store_dwordx4 v[48:51], v2, s[12:15], s30 offen sc1
    buffer_store_dwordx4 v[52:55], v2, s[12:15], s30 offen offset:1024 sc1
    s_lshl_b32 s31, s55, 1
    s_sub_u32 s31, 3, s31
    s_lshl_b32 s31, s31, 16
    s_add_u32 s30, s30, s31
    s_barrier
    ds_read_b128 v[56:59], v3
    ds_read_b128 v[60:63], v3 offset:1024
    s_waitcnt lgkmcnt(0)
    buffer_store_dwordx4 v[56:59], v2, s[12:15], s30 offen sc1
    buffer_store_dwordx4 v[60:63], v2, s[12:15], s30 offen offset:1024 sc1
    v_lshrrev_b32 v2, 4, v1
    v_and_b32 v3, 15, v1
    v_lshrrev_b32 v4, 2, v3
    v_lshl_add_u32 v4, v2, 2, v4
    v_lshrrev_b32 v5, 1, v4
    v_and_b32 v5, 3, v5
    v_xor_b32 v5, s29, v5
    v_lshlrev_b32 v4, 7, v4
    v_lshl_add_u32 v4, v5, 5, v4
    v_and_b32 v5, 3, v1
    v_lshl_add_u32 v4, v5, 3, v4
    v_add_u32 v4, 40960, v4
    ds_read_b64_tr_b16 v[160:161], v4 offset:0
    ds_read_b64_tr_b16 v[162:163], v4 offset:2048
    ds_read_b64_tr_b16 v[164:165], v4 offset:4096
    ds_read_b64_tr_b16 v[166:167], v4 offset:6144
    ds_read_b64_tr_b16 v[168:169], v4 offset:8192
    ds_read_b64_tr_b16 v[170:171], v4 offset:10240
    ds_read_b64_tr_b16 v[172:173], v4 offset:12288
    ds_read_b64_tr_b16 v[174:175], v4 offset:14336
    s_waitcnt lgkmcnt(0)
    ds_read_b64_tr_b16 v[176:177], v4 offset:16384
    ds_read_b64_tr_b16 v[178:179], v4 offset:18432
    ds_read_b64_tr_b16 v[180:181], v4 offset:20480
    ds_read_b64_tr_b16 v[182:183], v4 offset:22528
    ds_read_b64_tr_b16 v[184:185], v4 offset:24576
    ds_read_b64_tr_b16 v[186:187], v4 offset:26624
    ds_read_b64_tr_b16 v[188:189], v4 offset:28672
    ds_read_b64_tr_b16 v[190:191], v4 offset:30720
    s_waitcnt lgkmcnt(0)
L_oh_j:
    s_load_dwordx2 s[8:9], s[0:1], 16
    s_mov_b32 s10, 2097152
    s_waitcnt lgkmcnt(0)
    s_barrier
    s_cmp_ge_u32 s28, 4
    s_cbranch_scc1 L_g2_loader
    s_waitcnt vmcnt(0)
    v_mov_b32 v2, 163588
    v_mov_b32 v3, 1
    v_cmp_eq_u32 vcc, 0, v1
    s_and_saveexec_b64 s[46:47], vcc
    ds_add_rtn_u32 v4, v2, v3
    s_waitcnt lgkmcnt(0)
    s_mov_b64 exec, s[46:47]
    v_readfirstlane_b32 s30, v4
    s_cmp_lg_u32 s30, 3
    s_cbranch_scc1 L_oflag_36
    s_lshl_b32 s30, s34, 14
    s_add_u32 s30, s30, 12593920
    v_mov_b32 v3, 1
    v_cmp_eq_u32 vcc, 0, v1
    s_and_saveexec_b64 s[46:47], vcc
    buffer_store_dword v3, off, s[12:15], s30 sc1
    s_mov_b64 exec, s[46:47]
L_oflag_36:
    s_cmp_lg_u32 s28, 0
    s_cbranch_scc1 L_opoll_37_done
    v_min_u32 v2, 15, v1
    v_lshlrev_b32 v2, 14, v2
    s_lshl_b32 s30, s26, 18
    s_add_u32 s30, s30, 12593920
    s_mov_b32 s33, 400000
L_opoll_37:
    buffer_load_dword v3, v2, s[12:15], s30 offen sc1
    s_waitcnt vmcnt(0)
    v_cmp_ne_u32 vcc, 1, v3
    s_cmp_eq_u64 vcc, 0
    s_cbranch_scc1 L_opoll_37_done
    s_sleep 1
    s_sub_u32 s33, s33, 1
    s_cmp_lg_u32 s33, 0
    s_cbranch_scc1 L_opoll_37
    s_mov_b32 s54, 3
L_opoll_37_done:
    s_barrier
    v_lshrrev_b32 v3, 5, v1
    v_lshlrev_b32 v6, 4, v1
    v_add_u32 v8, 0, v6
    v_add_u32 v9, 49152, v6
    v_add_u32 v10, 98304, v6
    v_lshrrev_b32 v6, 4, v1
    v_and_b32 v6, 1, v6
    v_and_b32 v7, 15, v1
    v_lshrrev_b32 v7, 2, v7
    v_xor_b32 v14, s29, v7
    v_lshl_add_u32 v7, v3, 2, v7
    v_lshlrev_b32 v7, 8, v7
    v_lshl_add_u32 v7, v14, 6, v7
    v_lshl_add_u32 v7, v6, 5, v7
    v_and_b32 v6, 3, v1
    v_lshl_add_u32 v7, v6, 3, v7
    v_add_u32 v11, 16384, v7
    v_add_u32 v12, 65536, v7
    v_add_u32 v13, 114688, v7
    v_lshlrev_b32 v120, 16, v248
    v_and_b32 v121, 0xffff0000, v248
    v_lshlrev_b32 v122, 16, v249
    v_and_b32 v123, 0xffff0000, v249
    v_lshlrev_b32 v124, 16, v250
    v_and_b32 v125, 0xffff0000, v250
    v_lshlrev_b32 v126, 16, v251
    v_and_b32 v127, 0xffff0000, v251
    v_lshlrev_b32 v128, 16, v252
    v_and_b32 v129, 0xffff0000, v252
    v_lshlrev_b32 v130, 16, v253
    v_and_b32 v131, 0xffff0000, v253
    v_lshlrev_b32 v132, 16, v254
    v_and_b32 v133, 0xffff0000, v254
    v_lshlrev_b32 v134, 16, v255
    v_and_b32 v135, 0xffff0000, v255
    v_add_f32 v118, v120, v121
    v_add_f32 v118, v118, v122
    v_add_f32 v118, v118, v123
    v_add_f32 v118, v118, v124
    v_add_f32 v118, v118, v125
    v_add_f32 v118, v118, v126
    v_add_f32 v118, v118, v127
    v_add_f32 v118, v118, v128
    v_add_f32 v118, v118, v129
    v_add_f32 v118, v118, v130
    v_add_f32 v118, v118, v131
    v_add_f32 v118, v118, v132
    v_add_f32 v118, v118, v133
    v_add_f32 v118, v118, v134
    v_add_f32 v118, v118, v135
    v_mov_b32 v40, v118
    s_nop 1
    v_permlane32_swap_b32 v40, v118
    v_add_f32 v118, v118, v40
    v_and_b32 v2, 31, v1
    s_lshl_b32 s30, s29, 9
    s_add_u32 s30, s30, 147456
    v_lshl_add_u32 v119, v2, 4, s30
    s_setprio 1
    s_barrier
    ds_read_b128 v[16:19], v8 offset:0
    ds_read_b64_tr_b16 v[24:25], v11 offset:0
    ds_read_b64_tr_b16 v[26:27], v11 offset:2048
    ds_read_b128 v[20:23], v8 offset:8192
    ds_read_b128 v[28:31], v8 offset:1024
    ds_read_b64_tr_b16 v[36:37], v11 offset:4096
    ds_read_b64_tr_b16 v[38:39], v11 offset:6144
    ds_read_b128 v[32:35], v8 offset:9216
    s_waitcnt lgkmcnt(0)
    v_mfma_f32_32x32x16_bf16 v[64:79], v[24:27], v[16:19], 0
    ds_read_b128 v[40:43], v8 offset:2048
    ds_read_b64_tr_b16 v[48:49], v11 offset:8192
    ds_read_b64_tr_b16 v[50:51], v11 offset:10240
    v_mfma_f32_32x32x16_bf16 v[80:95], v[24:27], v[20:23], 0
    ds_read_b128 v[44:47], v8 offset:10240
    ds_read_b128 v[52:55], v8 offset:3072
    ds_read_b64_tr_b16 v[60:61], v11 offset:12288
    v_mfma_f32_32x32x16_bf16 v[64:79], v[36:39], v[28:31], v[64:79]
    ds_read_b64_tr_b16 v[62:63], v11 offset:14336
    ds_read_b128 v[56:59], v8 offset:11264
    v_mfma_f32_32x32x16_bf16 v[80:95], v[36:39], v[32:35], v[80:95]
    s_waitcnt lgkmcnt(0)
    v_mfma_f32_32x32x16_bf16 v[64:79], v[48:51], v[40:43], v[64:79]
    ds_read_b128 v[16:19], v8 offset:4096
    ds_read_b64_tr_b16 v[24:25], v11 offset:16384
    ds_read_b64_tr_b16 v[26:27], v11 offset:18432
    v_mfma_f32_32x32x16_bf16 v[80:95], v[48:51], v[44:47], v[80:95]
    ds_read_b128 v[20:23], v8 offset:12288
    ds_read_b128 v[28:31], v8 offset:5120
    ds_read_b64_tr_b16 v[36:37], v11 offset:20480
    v_mfma_f32_32x32x16_bf16 v[64:79], v[60:63], v[52:55], v[64:79]
    ds_read_b64_tr_b16 v[38:39], v11 offset:22528
    ds_read_b128 v[32:35], v8 offset:13312
    v_mfma_f32_32x32x16_bf16 v[80:95], v[60:63], v[56:59], v[80:95]
    s_waitcnt lgkmcnt(0)
    v_mfma_f32_32x32x16_bf16 v[64:79], v[24:27], v[16:19], v[64:79]
    ds_read_b128 v[40:43], v8 offset:6144
    ds_read_b64_tr_b16 v[48:49], v11 offset:24576
    ds_read_b64_tr_b16 v[50:51], v11 offset:26624
    v_mfma_f32_32x32x16_bf16 v[80:95], v[24:27], v[20:23], v[80:95]
    ds_read_b128 v[44:47], v8 offset:14336
    ds_read_b128 v[52:55], v8 offset:7168
    ds_read_b64_tr_b16 v[60:61], v11 offset:28672
    v_mfma_f32_32x32x16_bf16 v[64:79], v[36:39], v[28:31], v[64:79]
    ds_read_b64_tr_b16 v[62:63], v11 offset:30720
    ds_read_b128 v[56:59], v8 offset:15360
    v_mfma_f32_32x32x16_bf16 v[80:95], v[36:39], v[32:35], v[80:95]
    s_waitcnt lgkmcnt(0)
    v_mfma_f32_32x32x16_bf16 v[64:79], v[48:51], v[40:43], v[64:79]
    s_barrier
    ds_read_b128 v[16:19], v9 offset:0
    ds_read_b64_tr_b16 v[24:25], v12 offset:0
    ds_read_b64_tr_b16 v[26:27], v12 offset:2048
    v_mfma_f32_32x32x16_bf16 v[80:95], v[48:51], v[44:47], v[80:95]
    ds_read_b128 v[20:23], v9 offset:8192
    ds_read_b128 v[28:31], v9 offset:1024
    ds_read_b64_tr_b16 v[36:37], v12 offset:4096
    v_mfma_f32_32x32x16_bf16 v[64:79], v[60:63], v[52:55], v[64:79]
    ds_read_b64_tr_b16 v[38:39], v12 offset:6144
    ds_read_b128 v[32:35], v9 offset:9216
    v_mfma_f32_32x32x16_bf16 v[80:95], v[60:63], v[56:59], v[80:95]
    s_waitcnt lgkmcnt(0)
    v_mfma_f32_32x32x16_bf16 v[64:79], v[24:27], v[16:19], v[64:79]
    ds_read_b128 v[40:43], v9 offset:2048
    ds_read_b64_tr_b16 v[48:49], v12 offset:8192
    ds_read_b64_tr_b16 v[50:51], v12 offset:10240
    v_mfma_f32_32x32x16_bf16 v[80:95], v[24:27], v[20:23], v[80:95]
    ds_read_b128 v[44:47], v9 offset:10240
    ds_read_b128 v[52:55], v9 offset:3072
    ds_read_b64_tr_b16 v[60:61], v12 offset:12288
    v_mfma_f32_32x32x16_bf16 v[64:79], v[36:39], v[28:31], v[64:79]
    ds_read_b64_tr_b16 v[62:63], v12 offset:14336
    ds_read_b128 v[56:59], v9 offset:11264
    v_mfma_f32_32x32x16_bf16 v[80:95], v[36:39], v[32:35], v[80:95]
    s_waitcnt lgkmcnt(0)
    v_mfma_f32_32x32x16_bf16 v[64:79], v[48:51], v[40:43], v[64:79]
    ds_read_b128 v[16:19], v9 offset:4096
    ds_read_b64_tr_b16 v[24:25], v12 offset:16384
    ds_read_b64_tr_b16 v[26:27], v12 offset:18432
    v_mfma_f32_32x32x16_bf16 v[80:95], v[48:51], v[44:47], v[80:95]
    ds_read_b128 v[20:23], v9 offset:12288
    ds_read_b128 v[28:31], v9 offset:5120
    ds_read_b64_tr_b16 v[36:37], v12 offset:20480
    v_mfma_f32_32x32x16_bf16 v[64:79], v[60:63], v[52:55], v[64:79]
    ds_read_b64_tr_b16 v[38:39], v12 offset:22528
    ds_read_b128 v[32:35], v9 offset:13312
    v_mfma_f32_32x32x16_bf16 v[80:95], v[60:63], v[56:59], v[80:95]
    s_waitcnt lgkmcnt(0)
    v_mfma_f32_32x32x16_bf16 v[64:79], v[24:27], v[16:19], v[64:79]
    ds_read_b128 v[40:43], v9 offset:6144
    ds_read_b64_tr_b16 v[48:49], v12 offset:24576
    ds_read_b64_tr_b16 v[50:51], v12 offset:26624
    v_mfma_f32_32x32x16_bf16 v[80:95], v[24:27], v[20:23], v[80:95]
    ds_read_b128 v[44:47], v9 offset:14336
    ds_read_b128 v[52:55], v9 offset:7168
    ds_read_b64_tr_b16 v[60:61], v12 offset:28672
    v_mfma_f32_32x32x16_bf16 v[64:79], v[36:39], v[28:31], v[64:79]
    ds_read_b64_tr_b16 v[62:63], v12 offset:30720
    ds_read_b128 v[56:59], v9 offset:15360
    v_mfma_f32_32x32x16_bf16 v[80:95], v[36:39], v[32:35], v[80:95]
    s_waitcnt lgkmcnt(0)
    v_mfma_f32_32x32x16_bf16 v[64:79], v[48:51], v[40:43], v[64:79]
    s_barrier
    ds_read_b128 v[16:19], v10 offset:0
    ds_read_b64_tr_b16 v[24:25], v13 offset:0
    ds_read_b64_tr_b16 v[26:27], v13 offset:2048
    v_mfma_f32_32x32x16_bf16 v[80:95], v[48:51], v[44:47], v[80:95]
    ds_read_b128 v[20:23], v10 offset:8192
    ds_read_b128 v[28:31], v10 offset:1024
    ds_read_b64_tr_b16 v[36:37], v13 offset:4096
    v_mfma_f32_32x32x16_bf16 v[64:79], v[60:63], v[52:55], v[64:79]
    ds_read_b64_tr_b16 v[38:39], v13 offset:6144
    ds_read_b128 v[32:35], v10 offset:9216
    v_mfma_f32_32x32x16_bf16 v[80:95], v[60:63], v[56:59], v[80:95]
    s_waitcnt lgkmcnt(0)
    v_mfma_f32_32x32x16_bf16 v[64:79], v[24:27], v[16:19], v[64:79]
    ds_read_b128 v[40:43], v10 offset:2048
    ds_read_b64_tr_b16 v[48:49], v13 offset:8192
    ds_read_b64_tr_b16 v[50:51], v13 offset:10240
    v_mfma_f32_32x32x16_bf16 v[80:95], v[24:27], v[20:23], v[80:95]
    ds_read_b128 v[44:47], v10 offset:10240
    ds_read_b128 v[52:55], v10 offset:3072
    ds_read_b64_tr_b16 v[60:61], v13 offset:12288
    v_mfma_f32_32x32x16_bf16 v[64:79], v[36:39], v[28:31], v[64:79]
    ds_read_b64_tr_b16 v[62:63], v13 offset:14336
    ds_read_b128 v[56:59], v10 offset:11264
    v_mfma_f32_32x32x16_bf16 v[80:95], v[36:39], v[32:35], v[80:95]
    s_waitcnt lgkmcnt(0)
    v_mfma_f32_32x32x16_bf16 v[64:79], v[48:51], v[40:43], v[64:79]
    ds_read_b128 v[16:19], v10 offset:4096
    ds_read_b64_tr_b16 v[24:25], v13 offset:16384
    ds_read_b64_tr_b16 v[26:27], v13 offset:18432
    v_mfma_f32_32x32x16_bf16 v[80:95], v[48:51], v[44:47], v[80:95]
    ds_read_b128 v[20:23], v10 offset:12288
    ds_read_b128 v[28:31], v10 offset:5120
    ds_read_b64_tr_b16 v[36:37], v13 offset:20480
    v_mfma_f32_32x32x16_bf16 v[64:79], v[60:63], v[52:55], v[64:79]
    ds_read_b64_tr_b16 v[38:39], v13 offset:22528
    ds_read_b128 v[32:35], v10 offset:13312
    v_mfma_f32_32x32x16_bf16 v[80:95], v[60:63], v[56:59], v[80:95]
    s_waitcnt lgkmcnt(0)
    v_mfma_f32_32x32x16_bf16 v[64:79], v[24:27], v[16:19], v[64:79]
    ds_read_b128 v[40:43], v10 offset:6144
    ds_read_b64_tr_b16 v[48:49], v13 offset:24576
    ds_read_b64_tr_b16 v[50:51], v13 offset:26624
    v_mfma_f32_32x32x16_bf16 v[80:95], v[24:27], v[20:23], v[80:95]
    ds_read_b128 v[44:47], v10 offset:14336
    ds_read_b128 v[52:55], v10 offset:7168
    ds_read_b64_tr_b16 v[60:61], v13 offset:28672
    v_mfma_f32_32x32x16_bf16 v[64:79], v[36:39], v[28:31], v[64:79]
    ds_read_b64_tr_b16 v[62:63], v13 offset:30720
    ds_read_b128 v[56:59], v10 offset:15360
    v_mfma_f32_32x32x16_bf16 v[80:95], v[36:39], v[32:35], v[80:95]
    s_waitcnt lgkmcnt(0)
    v_mfma_f32_32x32x16_bf16 v[64:79], v[48:51], v[40:43], v[64:79]
    s_barrier
    ds_read_b128 v[16:19], v8 offset:0
    ds_read_b64_tr_b16 v[24:25], v11 offset:0
    ds_read_b64_tr_b16 v[26:27], v11 offset:2048
    v_mfma_f32_32x32x16_bf16 v[80:95], v[48:51], v[44:47], v[80:95]
    ds_read_b128 v[20:23], v8 offset:8192
    ds_read_b128 v[28:31], v8 offset:1024
    ds_read_b64_tr_b16 v[36:37], v11 offset:4096
    v_mfma_f32_32x32x16_bf16 v[64:79], v[60:63], v[52:55], v[64:79]
    ds_read_b64_tr_b16 v[38:39], v11 offset:6144
    ds_read_b128 v[32:35], v8 offset:9216
    v_mfma_f32_32x32x16_bf16 v[80:95], v[60:63], v[56:59], v[80:95]
    s_waitcnt lgkmcnt(0)
    v_mfma_f32_32x32x16_bf16 v[64:79], v[24:27], v[16:19], v[64:79]
    ds_read_b128 v[40:43], v8 offset:2048
    ds_read_b64_tr_b16 v[48:49], v11 offset:8192
    ds_read_b64_tr_b16 v[50:51], v11 offset:10240
    v_mfma_f32_32x32x16_bf16 v[80:95], v[24:27], v[20:23], v[80:95]
    ds_read_b128 v[44:47], v8 offset:10240
    ds_read_b128 v[52:55], v8 offset:3072
    ds_read_b64_tr_b16 v[60:61], v11 offset:12288
    v_mfma_f32_32x32x16_bf16 v[64:79], v[36:39], v[28:31], v[64:79]
    ds_read_b64_tr_b16 v[62:63], v11 offset:14336
    ds_read_b128 v[56:59], v8 offset:11264
    v_mfma_f32_32x32x16_bf16 v[80:95], v[36:39], v[32:35], v[80:95]
    s_waitcnt lgkmcnt(0)
    v_mfma_f32_32x32x16_bf16 v[64:79], v[48:51], v[40:43], v[64:79]
    ds_read_b128 v[16:19], v8 offset:4096
    ds_read_b64_tr_b16 v[24:25], v11 offset:16384
    ds_read_b64_tr_b16 v[26:27], v11 offset:18432
    v_mfma_f32_32x32x16_bf16 v[80:95], v[48:51], v[44:47], v[80:95]
    ds_read_b128 v[20:23], v8 offset:12288
    ds_read_b128 v[28:31], v8 offset:5120
    ds_read_b64_tr_b16 v[36:37], v11 offset:20480
    v_mfma_f32_32x32x16_bf16 v[64:79], v[60:63], v[52:55], v[64:79]
    ds_read_b64_tr_b16 v[38:39], v11 offset:22528
    ds_read_b128 v[32:35], v8 offset:13312
    v_mfma_f32_32x32x16_bf16 v[80:95], v[60:63], v[56:59], v[80:95]
    s_waitcnt lgkmcnt(0)
    v_mfma_f32_32x32x16_bf16 v[64:79], v[24:27], v[16:19], v[64:79]
    ds_read_b128 v[40:43], v8 offset:6144
    ds_read_b64_tr_b16 v[48:49], v11 offset:24576
    ds_read_b64_tr_b16 v[50:51], v11 offset:26624
    v_mfma_f32_32x32x16_bf16 v[80:95], v[24:27], v[20:23], v[80:95]
    ds_read_b128 v[44:47], v8 offset:14336
    ds_read_b128 v[52:55], v8 offset:7168
    ds_read_b64_tr_b16 v[60:61], v11 offset:28672
    v_mfma_f32_32x32x16_bf16 v[64:79], v[36:39], v[28:31], v[64:79]
    ds_read_b64_tr_b16 v[62:63], v11 offset:30720
    ds_read_b128 v[56:59], v8 offset:15360
    v_mfma_f32_32x32x16_bf16 v[80:95], v[36:39], v[32:35], v[80:95]
    s_waitcnt lgkmcnt(0)
    v_mfma_f32_32x32x16_bf16 v[64:79], v[48:51], v[40:43], v[64:79]
    s_barrier
    ds_read_b128 v[16:19], v9 offset:0
    ds_read_b64_tr_b16 v[24:25], v12 offset:0
    ds_read_b64_tr_b16 v[26:27], v12 offset:2048
    v_mfma_f32_32x32x16_bf16 v[80:95], v[48:51], v[44:47], v[80:95]
    ds_read_b128 v[20:23], v9 offset:8192
    ds_read_b128 v[28:31], v9 offset:1024
    ds_read_b64_tr_b16 v[36:37], v12 offset:4096
    v_mfma_f32_32x32x16_bf16 v[64:79], v[60:63], v[52:55], v[64:79]
    ds_read_b64_tr_b16 v[38:39], v12 offset:6144
    ds_read_b128 v[32:35], v9 offset:9216
    v_mfma_f32_32x32x16_bf16 v[80:95], v[60:63], v[56:59], v[80:95]
    s_waitcnt lgkmcnt(0)
    v_mfma_f32_32x32x16_bf16 v[64:79], v[24:27], v[16:19], v[64:79]
    ds_read_b128 v[40:43], v9 offset:2048
    ds_read_b64_tr_b16 v[48:49], v12 offset:8192
    ds_read_b64_tr_b16 v[50:51], v12 offset:10240
    v_mfma_f32_32x32x16_bf16 v[80:95], v[24:27], v[20:23], v[80:95]
    ds_read_b128 v[44:47], v9 offset:10240
    ds_read_b128 v[52:55], v9 offset:3072
    ds_read_b64_tr_b16 v[60:61], v12 offset:12288
    v_mfma_f32_32x32x16_bf16 v[64:79], v[36:39], v[28:31], v[64:79]
    ds_read_b64_tr_b16 v[62:63], v12 offset:14336
    ds_read_b128 v[56:59], v9 offset:11264
    v_mfma_f32_32x32x16_bf16 v[80:95], v[36:39], v[32:35], v[80:95]
    s_waitcnt lgkmcnt(0)
    v_mfma_f32_32x32x16_bf16 v[64:79], v[48:51], v[40:43], v[64:79]
    ds_read_b128 v[16:19], v9 offset:4096
    ds_read_b64_tr_b16 v[24:25], v12 offset:16384
    ds_read_b64_tr_b16 v[26:27], v12 offset:18432
    v_mfma_f32_32x32x16_bf16 v[80:95], v[48:51], v[44:47], v[80:95]
    ds_read_b128 v[20:23], v9 offset:12288
    ds_read_b128 v[28:31], v9 offset:5120
    ds_read_b64_tr_b16 v[36:37], v12 offset:20480
    v_mfma_f32_32x32x16_bf16 v[64:79], v[60:63], v[52:55], v[64:79]
    ds_read_b64_tr_b16 v[38:39], v12 offset:22528
    ds_read_b128 v[32:35], v9 offset:13312
    v_mfma_f32_32x32x16_bf16 v[80:95], v[60:63], v[56:59], v[80:95]
    s_waitcnt lgkmcnt(0)
    v_mfma_f32_32x32x16_bf16 v[64:79], v[24:27], v[16:19], v[64:79]
    ds_read_b128 v[40:43], v9 offset:6144
    ds_read_b64_tr_b16 v[48:49], v12 offset:24576
    ds_read_b64_tr_b16 v[50:51], v12 offset:26624
    v_mfma_f32_32x32x16_bf16 v[80:95], v[24:27], v[20:23], v[80:95]
    ds_read_b128 v[44:47], v9 offset:14336
    ds_read_b128 v[52:55], v9 offset:7168
    ds_read_b64_tr_b16 v[60:61], v12 offset:28672
    v_mfma_f32_32x32x16_bf16 v[64:79], v[36:39], v[28:31], v[64:79]
    ds_read_b64_tr_b16 v[62:63], v12 offset:30720
    ds_read_b128 v[56:59], v9 offset:15360
    v_mfma_f32_32x32x16_bf16 v[80:95], v[36:39], v[32:35], v[80:95]
    s_waitcnt lgkmcnt(0)
    v_mfma_f32_32x32x16_bf16 v[64:79], v[48:51], v[40:43], v[64:79]
    s_barrier
    ds_read_b128 v[16:19], v10 offset:0
    ds_read_b64_tr_b16 v[24:25], v13 offset:0
    ds_read_b64_tr_b16 v[26:27], v13 offset:2048
    v_mfma_f32_32x32x16_bf16 v[80:95], v[48:51], v[44:47], v[80:95]
    ds_read_b128 v[20:23], v10 offset:8192
    ds_read_b128 v[28:31], v10 offset:1024
    ds_read_b64_tr_b16 v[36:37], v13 offset:4096
    v_mfma_f32_32x32x16_bf16 v[64:79], v[60:63], v[52:55], v[64:79]
    ds_read_b64_tr_b16 v[38:39], v13 offset:6144
    ds_read_b128 v[32:35], v10 offset:9216
    v_mfma_f32_32x32x16_bf16 v[80:95], v[60:63], v[56:59], v[80:95]
    s_waitcnt lgkmcnt(0)
    v_mfma_f32_32x32x16_bf16 v[64:79], v[24:27], v[16:19], v[64:79]
    ds_read_b128 v[40:43], v10 offset:2048
    ds_read_b64_tr_b16 v[48:49], v13 offset:8192
    ds_read_b64_tr_b16 v[50:51], v13 offset:10240
    v_mfma_f32_32x32x16_bf16 v[80:95], v[24:27], v[20:23], v[80:95]
    ds_read_b128 v[44:47], v10 offset:10240
    ds_read_b128 v[52:55], v10 offset:3072
    ds_read_b64_tr_b16 v[60:61], v13 offset:12288
    v_mfma_f32_32x32x16_bf16 v[64:79], v[36:39], v[28:31], v[64:79]
    ds_read_b64_tr_b16 v[62:63], v13 offset:14336
    ds_read_b128 v[56:59], v10 offset:11264
    v_mfma_f32_32x32x16_bf16 v[80:95], v[36:39], v[32:35], v[80:95]
    s_waitcnt lgkmcnt(0)
    v_mfma_f32_32x32x16_bf16 v[64:79], v[48:51], v[40:43], v[64:79]
    ds_read_b128 v[16:19], v10 offset:4096
    ds_read_b64_tr_b16 v[24:25], v13 offset:16384
    ds_read_b64_tr_b16 v[26:27], v13 offset:18432
    v_mfma_f32_32x32x16_bf16 v[80:95], v[48:51], v[44:47], v[80:95]
    ds_read_b128 v[20:23], v10 offset:12288
    ds_read_b128 v[28:31], v10 offset:5120
    ds_read_b64_tr_b16 v[36:37], v13 offset:20480
    v_mfma_f32_32x32x16_bf16 v[64:79], v[60:63], v[52:55], v[64:79]
    ds_read_b64_tr_b16 v[38:39], v13 offset:22528
    ds_read_b128 v[32:35], v10 offset:13312
    v_mfma_f32_32x32x16_bf16 v[80:95], v[60:63], v[56:59], v[80:95]
    s_waitcnt lgkmcnt(0)
    v_mfma_f32_32x32x16_bf16 v[64:79], v[24:27], v[16:19], v[64:79]
    ds_read_b128 v[40:43], v10 offset:6144
    ds_read_b64_tr_b16 v[48:49], v13 offset:24576
    ds_read_b64_tr_b16 v[50:51], v13 offset:26624
    v_mfma_f32_32x32x16_bf16 v[80:95], v[24:27], v[20:23], v[80:95]
    ds_read_b128 v[44:47], v10 offset:14336
    ds_read_b128 v[52:55], v10 offset:7168
    ds_read_b64_tr_b16 v[60:61], v13 offset:28672
    v_mfma_f32_32x32x16_bf16 v[64:79], v[36:39], v[28:31], v[64:79]
    ds_read_b64_tr_b16 v[62:63], v13 offset:30720
    ds_read_b128 v[56:59], v10 offset:15360
    v_mfma_f32_32x32x16_bf16 v[80:95], v[36:39], v[32:35], v[80:95]
    s_waitcnt lgkmcnt(0)
    v_mfma_f32_32x32x16_bf16 v[64:79], v[48:51], v[40:43], v[64:79]
    s_barrier
    buffer_load_dwordx4 v[214:217], v230, s[4:7], s48 offen
    buffer_load_dwordx4 v[218:221], v230, s[4:7], s48 offen offset:32
    buffer_load_dwordx4 v[222:225], v230, s[4:7], s49 offen
    buffer_load_dwordx4 v[226:229], v230, s[4:7], s49 offen offset:32
    ds_read_b128 v[16:19], v8 offset:0
    ds_read_b64_tr_b16 v[24:25], v11 offset:0
    ds_read_b64_tr_b16 v[26:27], v11 offset:2048
    v_mfma_f32_32x32x16_bf16 v[80:95], v[48:51], v[44:47], v[80:95]
    ds_read_b128 v[20:23], v8 offset:8192
    ds_read_b128 v[28:31], v8 offset:1024
    ds_read_b64_tr_b16 v[36:37], v11 offset:4096
    v_mfma_f32_32x32x16_bf16 v[64:79], v[60:63], v[52:55], v[64:79]
    ds_read_b64_tr_b16 v[38:39], v11 offset:6144
    ds_read_b128 v[32:35], v8 offset:9216
    v_mfma_f32_32x32x16_bf16 v[80:95], v[60:63], v[56:59], v[80:95]
    s_waitcnt lgkmcnt(0)
    v_mfma_f32_32x32x16_bf16 v[64:79], v[24:27], v[16:19], v[64:79]
    ds_read_b128 v[40:43], v8 offset:2048
    ds_read_b64_tr_b16 v[48:49], v11 offset:8192
    ds_read_b64_tr_b16 v[50:51], v11 offset:10240
    v_mfma_f32_32x32x16_bf16 v[80:95], v[24:27], v[20:23], v[80:95]
    ds_read_b128 v[44:47], v8 offset:10240
    ds_read_b128 v[52:55], v8 offset:3072
    ds_read_b64_tr_b16 v[60:61], v11 offset:12288
    v_mfma_f32_32x32x16_bf16 v[64:79], v[36:39], v[28:31], v[64:79]
    ds_read_b64_tr_b16 v[62:63], v11 offset:14336
    ds_read_b128 v[56:59], v8 offset:11264
    v_mfma_f32_32x32x16_bf16 v[80:95], v[36:39], v[32:35], v[80:95]
    s_waitcnt lgkmcnt(0)
    v_mfma_f32_32x32x16_bf16 v[64:79], v[48:51], v[40:43], v[64:79]
    ds_read_b128 v[16:19], v8 offset:4096
    ds_read_b64_tr_b16 v[24:25], v11 offset:16384
    ds_read_b64_tr_b16 v[26:27], v11 offset:18432
    v_mfma_f32_32x32x16_bf16 v[80:95], v[48:51], v[44:47], v[80:95]
    ds_read_b128 v[20:23], v8 offset:12288
    ds_read_b128 v[28:31], v8 offset:5120
    ds_read_b64_tr_b16 v[36:37], v11 offset:20480
    v_mfma_f32_32x32x16_bf16 v[64:79], v[60:63], v[52:55], v[64:79]
    ds_read_b64_tr_b16 v[38:39], v11 offset:22528
    ds_read_b128 v[32:35], v8 offset:13312
    v_mfma_f32_32x32x16_bf16 v[80:95], v[60:63], v[56:59], v[80:95]
    s_waitcnt lgkmcnt(0)
    v_mfma_f32_32x32x16_bf16 v[64:79], v[24:27], v[16:19], v[64:79]
    ds_read_b128 v[40:43], v8 offset:6144
    ds_read_b64_tr_b16 v[48:49], v11 offset:24576
    ds_read_b64_tr_b16 v[50:51], v11 offset:26624
    v_mfma_f32_32x32x16_bf16 v[80:95], v[24:27], v[20:23], v[80:95]
    ds_read_b128 v[44:47], v8 offset:14336
    ds_read_b128 v[52:55], v8 offset:7168
    ds_read_b64_tr_b16 v[60:61], v11 offset:28672
    v_mfma_f32_32x32x16_bf16 v[64:79], v[36:39], v[28:31], v[64:79]
    ds_read_b64_tr_b16 v[62:63], v11 offset:30720
    ds_read_b128 v[56:59], v8 offset:15360
    v_mfma_f32_32x32x16_bf16 v[80:95], v[36:39], v[32:35], v[80:95]
    s_waitcnt lgkmcnt(0)
    v_mfma_f32_32x32x16_bf16 v[64:79], v[48:51], v[40:43], v[64:79]
    s_barrier
    ds_read_b128 v[16:19], v9 offset:0
    ds_read_b64_tr_b16 v[24:25], v12 offset:0
    ds_read_b64_tr_b16 v[26:27], v12 offset:2048
    v_mfma_f32_32x32x16_bf16 v[80:95], v[48:51], v[44:47], v[80:95]
    ds_read_b128 v[20:23], v9 offset:8192
    ds_read_b128 v[28:31], v9 offset:1024
    ds_read_b64_tr_b16 v[36:37], v12 offset:4096
    v_mfma_f32_32x32x16_bf16 v[64:79], v[60:63], v[52:55], v[64:79]
    ds_read_b64_tr_b16 v[38:39], v12 offset:6144
    ds_read_b128 v[32:35], v9 offset:9216
    v_mfma_f32_32x32x16_bf16 v[80:95], v[60:63], v[56:59], v[80:95]
    s_waitcnt lgkmcnt(0)
    v_mfma_f32_32x32x16_bf16 v[64:79], v[24:27], v[16:19], v[64:79]
    ds_read_b128 v[40:43], v9 offset:2048
    ds_read_b64_tr_b16 v[48:49], v12 offset:8192
    ds_read_b64_tr_b16 v[50:51], v12 offset:10240
    v_mfma_f32_32x32x16_bf16 v[80:95], v[24:27], v[20:23], v[80:95]
    ds_read_b128 v[44:47], v9 offset:10240
    ds_read_b128 v[52:55], v9 offset:3072
    ds_read_b64_tr_b16 v[60:61], v12 offset:12288
    v_mfma_f32_32x32x16_bf16 v[64:79], v[36:39], v[28:31], v[64:79]
    ds_read_b64_tr_b16 v[62:63], v12 offset:14336
    ds_read_b128 v[56:59], v9 offset:11264
    v_mfma_f32_32x32x16_bf16 v[80:95], v[36:39], v[32:35], v[80:95]
    s_waitcnt lgkmcnt(0)
    v_mfma_f32_32x32x16_bf16 v[64:79], v[48:51], v[40:43], v[64:79]
    ds_read_b128 v[16:19], v9 offset:4096
    ds_read_b64_tr_b16 v[24:25], v12 offset:16384
    ds_read_b64_tr_b16 v[26:27], v12 offset:18432
    v_mfma_f32_32x32x16_bf16 v[80:95], v[48:51], v[44:47], v[80:95]
    ds_read_b128 v[20:23], v9 offset:12288
    ds_read_b128 v[28:31], v9 offset:5120
    ds_read_b64_tr_b16 v[36:37], v12 offset:20480
    v_mfma_f32_32x32x16_bf16 v[64:79], v[60:63], v[52:55], v[64:79]
    ds_read_b64_tr_b16 v[38:39], v12 offset:22528
    ds_read_b128 v[32:35], v9 offset:13312
    v_mfma_f32_32x32x16_bf16 v[80:95], v[60:63], v[56:59], v[80:95]
    s_waitcnt lgkmcnt(0)
    v_mfma_f32_32x32x16_bf16 v[64:79], v[24:27], v[16:19], v[64:79]
    ds_read_b128 v[40:43], v9 offset:6144
    ds_read_b64_tr_b16 v[48:49], v12 offset:24576
    ds_read_b64_tr_b16 v[50:51], v12 offset:26624
    v_mfma_f32_32x32x16_bf16 v[80:95], v[24:27], v[20:23], v[80:95]
    ds_read_b128 v[44:47], v9 offset:14336
    ds_read_b128 v[52:55], v9 offset:7168
    ds_read_b64_tr_b16 v[60:61], v12 offset:28672
    v_mfma_f32_32x32x16_bf16 v[64:79], v[36:39], v[28:31], v[64:79]
    ds_read_b64_tr_b16 v[62:63], v12 offset:30720
    ds_read_b128 v[56:59], v9 offset:15360
    v_mfma_f32_32x32x16_bf16 v[80:95], v[36:39], v[32:35], v[80:95]
    s_waitcnt lgkmcnt(0)
    v_mfma_f32_32x32x16_bf16 v[64:79], v[48:51], v[40:43], v[64:79]
    v_mfma_f32_32x32x16_bf16 v[80:95], v[48:51], v[44:47], v[80:95]
    v_mfma_f32_32x32x16_bf16 v[64:79], v[60:63], v[52:55], v[64:79]
    v_mfma_f32_32x32x16_bf16 v[80:95], v[60:63], v[56:59], v[80:95]
    s_setprio 0
    s_waitcnt vmcnt(0)
    v_permlane32_swap_b32 v214, v216
    v_permlane32_swap_b32 v215, v217
    v_permlane32_swap_b32 v218, v220
    v_permlane32_swap_b32 v219, v221
    v_permlane32_swap_b32 v222, v224
    v_permlane32_swap_b32 v223, v225
    v_permlane32_swap_b32 v226, v228
    v_permlane32_swap_b32 v227, v229
    v_lshlrev_b32 v16, 16, v214
    v_and_b32 v17, 0xffff0000, v214
    v_lshlrev_b32 v18, 16, v215
    v_and_b32 v19, 0xffff0000, v215
    v_lshlrev_b32 v20, 16, v216
    v_and_b32 v21, 0xffff0000, v216
    v_lshlrev_b32 v22, 16, v217
    v_and_b32 v23, 0xffff0000, v217
    v_lshlrev_b32 v24, 16, v218
    v_and_b32 v25, 0xffff0000, v218
    v_lshlrev_b32 v26, 16, v219
    v_and_b32 v27, 0xffff0000, v219
    v_lshlrev_b32 v28, 16, v220
    v_and_b32 v29, 0xffff0000, v220
    v_lshlrev_b32 v30, 16, v221
    v_and_b32 v31, 0xffff0000, v221
    v_lshlrev_b32 v32, 16, v222
    v_and_b32 v33, 0xffff0000, v222
    v_lshlrev_b32 v34, 16, v223
    v_and_b32 v35, 0xffff0000, v223
    v_lshlrev_b32 v36, 16, v224
    v_and_b32 v37, 0xffff0000, v224
    v_lshlrev_b32 v38, 16, v225
    v_and_b32 v39, 0xffff0000, v225
    v_lshlrev_b32 v40, 16, v226
    v_and_b32 v41, 0xffff0000, v226
    v_lshlrev_b32 v42, 16, v227
    v_and_b32 v43, 0xffff0000, v227
    v_lshlrev_b32 v44, 16, v228
    v_and_b32 v45, 0xffff0000, v228
    v_lshlrev_b32 v46, 16, v229
    v_and_b32 v47, 0xffff0000, v229
    v_pk_add_f32 v[64:65], v[64:65], v[16:17]
    v_pk_add_f32 v[66:67], v[66:67], v[18:19]
    v_pk_add_f32 v[68:69], v[68:69], v[20:21]
    v_pk_add_f32 v[70:71], v[70:71], v[22:23]
    v_pk_add_f32 v[72:73], v[72:73], v[24:25]
    v_pk_add_f32 v[74:75], v[74:75], v[26:27]
    v_pk_add_f32 v[76:77], v[76:77], v[28:29]
    v_pk_add_f32 v[78:79], v[78:79], v[30:31]
    v_pk_add_f32 v[80:81], v[80:81], v[32:33]
    v_pk_add_f32 v[82:83], v[82:83], v[34:35]
    v_pk_add_f32 v[84:85], v[84:85], v[36:37]
    v_pk_add_f32 v[86:87], v[86:87], v[38:39]
    v_pk_add_f32 v[88:89], v[88:89], v[40:41]
    v_pk_add_f32 v[90:91], v[90:91], v[42:43]
    v_pk_add_f32 v[92:93], v[92:93], v[44:45]
    v_pk_add_f32 v[94:95], v[94:95], v[46:47]
    v_pk_add_f32 v[56:57], v[64:65], v[66:67]
    v_pk_mul_f32 v[58:59], v[64:65], v[120:121]
    v_pk_add_f32 v[60:61], v[80:81], v[82:83]
    v_pk_mul_f32 v[62:63], v[80:81], v[120:121]
    v_pk_fma_f32 v[58:59], v[66:67], v[122:123], v[58:59]
    v_pk_fma_f32 v[62:63], v[82:83], v[122:123], v[62:63]
    v_pk_add_f32 v[56:57], v[56:57], v[68:69]
    v_pk_fma_f32 v[58:59], v[68:69], v[124:125], v[58:59]
    v_pk_add_f32 v[60:61], v[60:61], v[84:85]
    v_pk_fma_f32 v[62:63], v[84:85], v[124:125], v[62:63]
    v_pk_add_f32 v[56:57], v[56:57], v[70:71]
    v_pk_fma_f32 v[58:59], v[70:71], v[126:127], v[58:59]
    v_pk_add_f32 v[60:61], v[60:61], v[86:87]
    v_pk_fma_f32 v[62:63], v[86:87], v[126:127], v[62:63]
    v_pk_add_f32 v[56:57], v[56:57], v[72:73]
    v_pk_fma_f32 v[58:59], v[72:73], v[128:129], v[58:59]
    v_pk_add_f32 v[60:61], v[60:61], v[88:89]
    v_pk_fma_f32 v[62:63], v[88:89], v[128:129], v[62:63]
    v_pk_add_f32 v[56:57], v[56:57], v[74:75]
    v_pk_fma_f32 v[58:59], v[74:75], v[130:131], v[58:59]
    v_pk_add_f32 v[60:61], v[60:61], v[90:91]
    v_pk_fma_f32 v[62:63], v[90:91], v[130:131], v[62:63]
    v_pk_add_f32 v[56:57], v[56:57], v[76:77]
    v_pk_fma_f32 v[58:59], v[76:77], v[132:133], v[58:59]
    v_pk_add_f32 v[60:61], v[60:61], v[92:93]
    v_pk_fma_f32 v[62:63], v[92:93], v[132:133], v[62:63]
    v_pk_add_f32 v[56:57], v[56:57], v[78:79]
    v_pk_fma_f32 v[58:59], v[78:79], v[134:135], v[58:59]
    v_pk_add_f32 v[60:61], v[60:61], v[94:95]
    v_pk_fma_f32 v[62:63], v[94:95], v[134:135], v[62:63]
    v_add_f32 v48, v56, v57
    v_add_f32 v50, v58, v59
    v_add_f32 v52, v60, v61
    v_add_f32 v54, v62, v63
    v_mov_b32 v56, v48
    v_mov_b32 v57, v52
    v_mov_b32 v58, v50
    v_mov_b32 v59, v54
    s_nop 1
    v_permlane32_swap_b32 v56, v48
    v_permlane32_swap_b32 v57, v52
    v_permlane32_swap_b32 v58, v50
    v_permlane32_swap_b32 v59, v54
    v_add_f32 v48, v48, v56
    v_add_f32 v52, v52, v57
    v_add_f32 v50, v50, v58
    v_add_f32 v54, v54, v59
    v_mul_f32 v56, 0xbd000000, v48
    v_mov_b32 v51, v118
    v_mul_f32 v58, 0xbd000000, v52
    v_mov_b32 v55, v118
    v_pk_add_f32 v[16:17], v[64:65], v[56:57] op_sel_hi:[1,0]
    v_pk_add_f32 v[18:19], v[66:67], v[56:57] op_sel_hi:[1,0]
    v_pk_add_f32 v[20:21], v[68:69], v[56:57] op_sel_hi:[1,0]
    v_pk_add_f32 v[22:23], v[70:71], v[56:57] op_sel_hi:[1,0]
    v_pk_add_f32 v[24:25], v[72:73], v[56:57] op_sel_hi:[1,0]
    v_pk_add_f32 v[26:27], v[74:75], v[56:57] op_sel_hi:[1,0]
    v_pk_add_f32 v[28:29], v[76:77], v[56:57] op_sel_hi:[1,0]
    v_pk_add_f32 v[30:31], v[78:79], v[56:57] op_sel_hi:[1,0]
    v_pk_add_f32 v[32:33], v[80:81], v[58:59] op_sel_hi:[1,0]
    v_pk_add_f32 v[34:35], v[82:83], v[58:59] op_sel_hi:[1,0]
    v_pk_add_f32 v[36:37], v[84:85], v[58:59] op_sel_hi:[1,0]
    v_pk_add_f32 v[38:39], v[86:87], v[58:59] op_sel_hi:[1,0]
    v_pk_add_f32 v[40:41], v[88:89], v[58:59] op_sel_hi:[1,0]
    v_pk_add_f32 v[42:43], v[90:91], v[58:59] op_sel_hi:[1,0]
    v_pk_add_f32 v[44:45], v[92:93], v[58:59] op_sel_hi:[1,0]
    v_pk_add_f32 v[46:47], v[94:95], v[58:59] op_sel_hi:[1,0]
    v_pk_mul_f32 v[60:61], v[16:17], v[16:17]
    v_pk_mul_f32 v[62:63], v[32:33], v[32:33]
    v_pk_fma_f32 v[60:61], v[18:19], v[18:19], v[60:61]
    v_pk_fma_f32 v[62:63], v[34:35], v[34:35], v[62:63]
    v_pk_fma_f32 v[60:61], v[20:21], v[20:21], v[60:61]
    v_pk_fma_f32 v[62:63], v[36:37], v[36:37], v[62:63]
    v_pk_fma_f32 v[60:61], v[22:23], v[22:23], v[60:61]
    v_pk_fma_f32 v[62:63], v[38:39], v[38:39], v[62:63]
    v_pk_fma_f32 v[60:61], v[24:25], v[24:25], v[60:61]
    v_pk_fma_f32 v[62:63], v[40:41], v[40:41], v[62:63]
    v_pk_fma_f32 v[60:61], v[26:27], v[26:27], v[60:61]
    v_pk_fma_f32 v[62:63], v[42:43], v[42:43], v[62:63]
    v_pk_fma_f32 v[60:61], v[28:29], v[28:29], v[60:61]
    v_pk_fma_f32 v[62:63], v[44:45], v[44:45], v[62:63]
    v_pk_fma_f32 v[60:61], v[30:31], v[30:31], v[60:61]
    v_pk_fma_f32 v[62:63], v[46:47], v[46:47], v[62:63]
    v_add_f32 v49, v60, v61
    v_add_f32 v53, v62, v63
    v_mov_b32 v56, v49
    v_mov_b32 v57, v53
    s_nop 1
    v_permlane32_swap_b32 v56, v49
    v_permlane32_swap_b32 v57, v53
    v_add_f32 v49, v49, v56
    v_add_f32 v53, v53, v57
    s_mov_b64 s[46:47], exec
    s_mov_b32 exec_hi, 0
    ds_write_b128 v119, v[48:51]
    ds_write_b128 v119, v[52:55] offset:2048
    s_mov_b64 exec, s[46:47]
    s_waitcnt lgkmcnt(0)
    s_barrier
    s_barrier
    v_and_b32 v2, 31, v1
    v_lshlrev_b32 v3, 2, v2
    v_add_u32 v3, 147456, v3
    v_mov_b32 v4, 152064
    ds_read_b32 v8, v3 offset:4096
    ds_read_b32 v9, v3 offset:4352
    ds_read_b32 v10, v3 offset:4224
    ds_read_b32 v11, v3 offset:4480
    ds_read_b64 v[6:7], v4
    v_lshrrev_b32 v3, 5, v1
    s_lshl_b32 s30, s59, 8
    s_lshl_b32 s31, s29, 6
    s_add_u32 s30, s30, s31
    v_lshl_add_u32 v5, v3, 4, s30
    v_lshl_add_u32 v136, v2, 11, v5
    v_mov_b32 v137, v2
    v_add_u32 v138, 32, v2
    s_waitcnt lgkmcnt(0)
    v_readfirstlane_b32 s62, v6
    v_readfirstlane_b32 s63, v7
    v_sub_f32 v8, 0, v8
    v_sub_f32 v10, 0, v10
    v_pk_add_f32 v[16:17], v[64:65], v[8:9] op_sel_hi:[1,0]
    v_pk_add_f32 v[18:19], v[66:67], v[8:9] op_sel_hi:[1,0]
    v_pk_add_f32 v[20:21], v[68:69], v[8:9] op_sel_hi:[1,0]
    v_pk_add_f32 v[22:23], v[70:71], v[8:9] op_sel_hi:[1,0]
    v_pk_add_f32 v[24:25], v[72:73], v[8:9] op_sel_hi:[1,0]
    v_pk_add_f32 v[26:27], v[74:75], v[8:9] op_sel_hi:[1,0]
    v_pk_add_f32 v[28:29], v[76:77], v[8:9] op_sel_hi:[1,0]
    v_pk_add_f32 v[30:31], v[78:79], v[8:9] op_sel_hi:[1,0]
    v_pk_mul_f32 v[16:17], v[16:17], v[8:9] op_sel:[0,1] op_sel_hi:[1,1]
    v_pk_mul_f32 v[18:19], v[18:19], v[8:9] op_sel:[0,1] op_sel_hi:[1,1]
    v_pk_mul_f32 v[20:21], v[20:21], v[8:9] op_sel:[0,1] op_sel_hi:[1,1]
    v_pk_mul_f32 v[22:23], v[22:23], v[8:9] op_sel:[0,1] op_sel_hi:[1,1]
    v_pk_mul_f32 v[24:25], v[24:25], v[8:9] op_sel:[0,1] op_sel_hi:[1,1]
    v_pk_mul_f32 v[26:27], v[26:27], v[8:9] op_sel:[0,1] op_sel_hi:[1,1]
    v_pk_mul_f32 v[28:29], v[28:29], v[8:9] op_sel:[0,1] op_sel_hi:[1,1]
    v_pk_mul_f32 v[30:31], v[30:31], v[8:9] op_sel:[0,1] op_sel_hi:[1,1]
    v_pk_add_f32 v[64:65], v[64:65], v[16:17]
    v_pk_add_f32 v[66:67], v[66:67], v[18:19]
    v_pk_add_f32 v[68:69], v[68:69], v[20:21]
    v_pk_add_f32 v[70:71], v[70:71], v[22:23]
    v_pk_add_f32 v[72:73], v[72:73], v[24:25]
    v_pk_add_f32 v[74:75], v[74:75], v[26:27]
    v_pk_add_f32 v[76:77], v[76:77], v[28:29]
    v_pk_add_f32 v[78:79], v[78:79], v[30:31]
    v_pk_add_f32 v[32:33], v[80:81], v[10:11] op_sel_hi:[1,0]
    v_pk_add_f32 v[34:35], v[82:83], v[10:11] op_sel_hi:[1,0]
    v_pk_add_f32 v[36:37], v[84:85], v[10:11] op_sel_hi:[1,0]
    v_pk_add_f32 v[38:39], v[86:87], v[10:11] op_sel_hi:[1,0]
    v_pk_add_f32 v[40:41], v[88:89], v[10:11] op_sel_hi:[1,0]
    v_pk_add_f32 v[42:43], v[90:91], v[10:11] op_sel_hi:[1,0]
    v_pk_add_f32 v[44:45], v[92:93], v[10:11] op_sel_hi:[1,0]
    v_pk_add_f32 v[46:47], v[94:95], v[10:11] op_sel_hi:[1,0]
    v_pk_mul_f32 v[32:33], v[32:33], v[10:11] op_sel:[0,1] op_sel_hi:[1,1]
    v_pk_mul_f32 v[34:35], v[34:35], v[10:11] op_sel:[0,1] op_sel_hi:[1,1]
    v_pk_mul_f32 v[36:37], v[36:37], v[10:11] op_sel:[0,1] op_sel_hi:[1,1]
    v_pk_mul_f32 v[38:39], v[38:39], v[10:11] op_sel:[0,1] op_sel_hi:[1,1]
    v_pk_mul_f32 v[40:41], v[40:41], v[10:11] op_sel:[0,1] op_sel_hi:[1,1]
    v_pk_mul_f32 v[42:43], v[42:43], v[10:11] op_sel:[0,1] op_sel_hi:[1,1]
    v_pk_mul_f32 v[44:45], v[44:45], v[10:11] op_sel:[0,1] op_sel_hi:[1,1]
    v_pk_mul_f32 v[46:47], v[46:47], v[10:11] op_sel:[0,1] op_sel_hi:[1,1]
    v_pk_add_f32 v[80:81], v[80:81], v[32:33]
    v_pk_add_f32 v[82:83], v[82:83], v[34:35]
    v_pk_add_f32 v[84:85], v[84:85], v[36:37]
    v_pk_add_f32 v[86:87], v[86:87], v[38:39]
    v_pk_add_f32 v[88:89], v[88:89], v[40:41]
    v_pk_add_f32 v[90:91], v[90:91], v[42:43]
    v_pk_add_f32 v[92:93], v[92:93], v[44:45]
    v_pk_add_f32 v[94:95], v[94:95], v[46:47]
    v_lshrrev_b32 v3, 5, v1
    s_lshl_b32 s31, s29, 6
    v_lshl_add_u32 v4, v3, 3, s31
    s_lshl_b32 s31, s29, 7
    v_lshl_add_u32 v5, v3, 4, s31
    s_lshl_b32 s48, s34, 14
    s_add_u32 s48, s48, 12582912
    s_lshr_b32 s30, s62, 5
    s_cmp_lg_u32 s30, 0
    s_cbranch_scc1 L_cand_38
    v_cvt_pk_bf16_f32 v192, v16, v17
    v_cvt_pk_bf16_f32 v193, v18, v19
    v_cvt_pk_bf16_f32 v194, v20, v21
    v_cvt_pk_bf16_f32 v195, v22, v23
    v_cvt_pk_bf16_f32 v196, v24, v25
    v_cvt_pk_bf16_f32 v197, v26, v27
    v_cvt_pk_bf16_f32 v198, v28, v29
    v_cvt_pk_bf16_f32 v199, v30, v31
    s_add_u32 s31, s48, 9216
    s_add_u32 s32, s48, 9728
    v_cmp_eq_u32 vcc, s62, v137
    s_and_saveexec_b64 s[46:47], vcc
    buffer_store_dwordx2 v[192:193], v4, s[12:15], s31 offen sc1
    buffer_store_dwordx2 v[194:195], v4, s[12:15], s31 offen offset:16 sc1
    buffer_store_dwordx2 v[196:197], v4, s[12:15], s31 offen offset:32 sc1
    buffer_store_dwordx2 v[198:199], v4, s[12:15], s31 offen offset:48 sc1
    buffer_store_dwordx4 v[64:67], v5, s[12:15], s32 offen sc1
    buffer_store_dwordx4 v[68:71], v5, s[12:15], s32 offen offset:32 sc1
    buffer_store_dwordx4 v[72:75], v5, s[12:15], s32 offen offset:64 sc1
    buffer_store_dwordx4 v[76:79], v5, s[12:15], s32 offen offset:96 sc1
    s_mov_b64 exec, s[46:47]
L_cand_38:
    s_lshr_b32 s30, s62, 5
    s_cmp_lg_u32 s30, 1
    s_cbranch_scc1 L_cand_39
    v_cvt_pk_bf16_f32 v192, v32, v33
    v_cvt_pk_bf16_f32 v193, v34, v35
    v_cvt_pk_bf16_f32 v194, v36, v37
    v_cvt_pk_bf16_f32 v195, v38, v39
    v_cvt_pk_bf16_f32 v196, v40, v41
    v_cvt_pk_bf16_f32 v197, v42, v43
    v_cvt_pk_bf16_f32 v198, v44, v45
    v_cvt_pk_bf16_f32 v199, v46, v47
    s_add_u32 s31, s48, 9216
    s_add_u32 s32, s48, 9728
    v_cmp_eq_u32 vcc, s62, v138
    s_and_saveexec_b64 s[46:47], vcc
    buffer_store_dwordx2 v[192:193], v4, s[12:15], s31 offen sc1
    buffer_store_dwordx2 v[194:195], v4, s[12:15], s31 offen offset:16 sc1
    buffer_store_dwordx2 v[196:197], v4, s[12:15], s31 offen offset:32 sc1
    buffer_store_dwordx2 v[198:199], v4, s[12:15], s31 offen offset:48 sc1
    buffer_store_dwordx4 v[80:83], v5, s[12:15], s32 offen sc1
    buffer_store_dwordx4 v[84:87], v5, s[12:15], s32 offen offset:32 sc1
    buffer_store_dwordx4 v[88:91], v5, s[12:15], s32 offen offset:64 sc1
    buffer_store_dwordx4 v[92:95], v5, s[12:15], s32 offen offset:96 sc1
    s_mov_b64 exec, s[46:47]
L_cand_39:
    s_lshr_b32 s30, s63, 5
    s_cmp_lg_u32 s30, 0
    s_cbranch_scc1 L_cand_40
    v_cvt_pk_bf16_f32 v192, v16, v17
    v_cvt_pk_bf16_f32 v193, v18, v19
    v_cvt_pk_bf16_f32 v194, v20, v21
    v_cvt_pk_bf16_f32 v195, v22, v23
    v_cvt_pk_bf16_f32 v196, v24, v25
    v_cvt_pk_bf16_f32 v197, v26, v27
    v_cvt_pk_bf16_f32 v198, v28, v29
    v_cvt_pk_bf16_f32 v199, v30, v31
    s_add_u32 s31, s48, 9472
    s_add_u32 s32, s48, 10240
    v_cmp_eq_u32 vcc, s63, v137
    s_and_saveexec_b64 s[46:47], vcc
    buffer_store_dwordx2 v[192:193], v4, s[12:15], s31 offen sc1
    buffer_store_dwordx2 v[194:195], v4, s[12:15], s31 offen offset:16 sc1
    buffer_store_dwordx2 v[196:197], v4, s[12:15], s31 offen offset:32 sc1
    buffer_store_dwordx2 v[198:199], v4, s[12:15], s31 offen offset:48 sc1
    buffer_store_dwordx4 v[64:67], v5, s[12:15], s32 offen sc1
    buffer_store_dwordx4 v[68:71], v5, s[12:15], s32 offen offset:32 sc1
    buffer_store_dwordx4 v[72:75], v5, s[12:15], s32 offen offset:64 sc1
    buffer_store_dwordx4 v[76:79], v5, s[12:15], s32 offen offset:96 sc1
    s_mov_b64 exec, s[46:47]
L_cand_40:
    s_lshr_b32 s30, s63, 5
    s_cmp_lg_u32 s30, 1
    s_cbranch_scc1 L_cand_41
    v_cvt_pk_bf16_f32 v192, v32, v33
    v_cvt_pk_bf16_f32 v193, v34, v35
    v_cvt_pk_bf16_f32 v194, v36, v37
    v_cvt_pk_bf16_f32 v195, v38, v39
    v_cvt_pk_bf16_f32 v196, v40, v41
    v_cvt_pk_bf16_f32 v197, v42, v43
    v_cvt_pk_bf16_f32 v198, v44, v45
    v_cvt_pk_bf16_f32 v199, v46, v47
    s_add_u32 s31, s48, 9472
    s_add_u32 s32, s48, 10240
    v_cmp_eq_u32 vcc, s63, v138
    s_and_saveexec_b64 s[46:47], vcc
    buffer_store_dwordx2 v[192:193], v4, s[12:15], s31 offen sc1
    buffer_store_dwordx2 v[194:195], v4, s[12:15], s31 offen offset:16 sc1
    buffer_store_dwordx2 v[196:197], v4, s[12:15], s31 offen offset:32 sc1
    buffer_store_dwordx2 v[198:199], v4, s[12:15], s31 offen offset:48 sc1
    buffer_store_dwordx4 v[80:83], v5, s[12:15], s32 offen sc1
    buffer_store_dwordx4 v[84:87], v5, s[12:15], s32 offen offset:32 sc1
    buffer_store_dwordx4 v[88:91], v5, s[12:15], s32 offen offset:64 sc1
    buffer_store_dwordx4 v[92:95], v5, s[12:15], s32 offen offset:96 sc1
    s_mov_b64 exec, s[46:47]
L_cand_41:
    v_cvt_pk_bf16_f32 v192, v64, v65
    v_cvt_pk_bf16_f32 v193, v66, v67
    v_cvt_pk_bf16_f32 v194, v68, v69
    v_cvt_pk_bf16_f32 v195, v70, v71
    v_cvt_pk_bf16_f32 v196, v72, v73
    v_cvt_pk_bf16_f32 v197, v74, v75
    v_cvt_pk_bf16_f32 v198, v76, v77
    v_cvt_pk_bf16_f32 v199, v78, v79
    s_nop 1
    v_permlane32_swap_b32 v192, v194
    v_permlane32_swap_b32 v193, v195
    v_permlane32_swap_b32 v196, v198
    v_permlane32_swap_b32 v197, v199
    v_cvt_pk_bf16_f32 v200, v80, v81
    v_cvt_pk_bf16_f32 v201, v82, v83
    v_cvt_pk_bf16_f32 v202, v84, v85
    v_cvt_pk_bf16_f32 v203, v86, v87
    v_cvt_pk_bf16_f32 v204, v88, v89
    v_cvt_pk_bf16_f32 v205, v90, v91
    v_cvt_pk_bf16_f32 v206, v92, v93
    v_cvt_pk_bf16_f32 v207, v94, v95
    s_nop 1
    v_permlane32_swap_b32 v200, v202
    v_permlane32_swap_b32 v201, v203
    v_permlane32_swap_b32 v204, v206
    v_permlane32_swap_b32 v205, v207
    s_lshl_b32 s49, s58, 17
    s_add_u32 s50, s49, 65536
    v_cmp_ne_u32 vcc, s62, v137
    v_cmp_ne_u32 s[52:53], s63, v137
    s_and_b64 vcc, vcc, s[52:53]
    s_and_saveexec_b64 s[46:47], vcc
    buffer_store_dwordx4 v[192:195], v136, s[16:19], s49 offen nt
    buffer_store_dwordx4 v[196:199], v136, s[16:19], s49 offen offset:32 nt
    s_mov_b64 exec, s[46:47]
    v_cmp_ne_u32 vcc, s62, v138
    v_cmp_ne_u32 s[52:53], s63, v138
    s_and_b64 vcc, vcc, s[52:53]
    s_and_saveexec_b64 s[46:47], vcc
    buffer_store_dwordx4 v[200:203], v136, s[16:19], s50 offen nt
    buffer_store_dwordx4 v[204:207], v136, s[16:19], s50 offen offset:32 nt
    s_mov_b64 exec, s[46:47]
    v_lshlrev_b32 v2, 2, v0
    v_add_u32 v2, 98304, v2
    ds_read_b32 v232, v2 offset:0
    ds_read_b32 v233, v2 offset:2048
    ds_read_b32 v234, v2 offset:4096
    ds_read_b32 v235, v2 offset:6144
    ds_read_b32 v236, v2 offset:8192
    ds_read_b32 v237, v2 offset:10240
    ds_read_b32 v238, v2 offset:12288
    ds_read_b32 v239, v2 offset:14336
    s_waitcnt lgkmcnt(0)
    ds_read_b32 v240, v2 offset:16384
    ds_read_b32 v241, v2 offset:18432
    ds_read_b32 v242, v2 offset:20480
    ds_read_b32 v243, v2 offset:22528
    ds_read_b32 v244, v2 offset:24576
    ds_read_b32 v245, v2 offset:26624
    ds_read_b32 v246, v2 offset:28672
    ds_read_b32 v247, v2 offset:30720
    s_waitcnt lgkmcnt(0)
    v_lshlrev_b32 v96, 16, v232
    v_and_b32 v97, 0xffff0000, v232
    v_lshlrev_b32 v98, 16, v233
    v_and_b32 v99, 0xffff0000, v233
    v_lshlrev_b32 v100, 16, v234
    v_and_b32 v101, 0xffff0000, v234
    v_lshlrev_b32 v102, 16, v235
    v_and_b32 v103, 0xffff0000, v235
    v_lshlrev_b32 v104, 16, v236
    v_and_b32 v105, 0xffff0000, v236
    v_lshlrev_b32 v106, 16, v237
    v_and_b32 v107, 0xffff0000, v237
    v_lshlrev_b32 v108, 16, v238
    v_and_b32 v109, 0xffff0000, v238
    v_lshlrev_b32 v110, 16, v239
    v_and_b32 v111, 0xffff0000, v239
    v_lshlrev_b32 v112, 16, v240
    v_and_b32 v113, 0xffff0000, v240
    v_lshlrev_b32 v114, 16, v241
    v_and_b32 v115, 0xffff0000, v241
    v_lshlrev_b32 v116, 16, v242
    v_and_b32 v117, 0xffff0000, v242
    v_lshlrev_b32 v118, 16, v243
    v_and_b32 v119, 0xffff0000, v243
    v_lshlrev_b32 v120, 16, v244
    v_and_b32 v121, 0xffff0000, v244
    v_lshlrev_b32 v122, 16, v245
    v_and_b32 v123, 0xffff0000, v245
    v_lshlrev_b32 v124, 16, v246
    v_and_b32 v125, 0xffff0000, v246
    v_lshlrev_b32 v126, 16, v247
    v_and_b32 v127, 0xffff0000, v247
    v_lshrrev_b32 v2, 4, v1
    v_and_b32 v5, 1, v1
    v_lshlrev_b32 v5, 11, v5
    v_lshl_add_u32 v5, v2, 3, v5
    s_and_b32 s30, s34, 3
    s_lshl_b32 s31, s30, 9
    s_add_u32 s31, s31, 152192
    v_add_u32 v144, s31, v5
    v_and_b32 v3, 15, v1
    v_lshlrev_b32 v6, 6, v3
    v_lshl_add_u32 v145, v2, 4, v6
    s_lshl_b32 s42, s34, 14
    s_xor_b32 s31, s28, 4
    s_lshl_b32 s31, s31, 7
    s_add_u32 s40, s42, s31
    s_add_u32 s40, s40, 12594048
    s_add_u32 s42, s42, 12582912
    v_lshlrev_b32 v148, 4, v0
    v_lshlrev_b32 v6, 14, v2
    v_bfe_u32 v3, v1, 3, 1
    v_lshl_add_u32 v6, v3, 9, v6
    v_and_b32 v3, 7, v1
    v_lshl_add_u32 v146, v3, 4, v6
    s_lshl_b32 s31, s30, 7
    s_andn2_b32 s30, s34, 3
    s_lshl_b32 s30, s30, 14
    s_add_u32 s30, s30, s31
    s_add_u32 s41, s30, 12594048
    v_and_b32 v2, 3, v1
    v_bfe_u32 v3, v1, 2, 1
    v_lshlrev_b32 v2, 5, v2
    v_lshl_add_u32 v2, v3, 2, v2
    v_add_u32 v149, 159360, v2
    s_lshr_b32 s44, s34, 2
    v_lshrrev_b32 v2, 3, v1
    v_and_b32 v3, 7, v1
    v_lshlrev_b32 v4, 14, v2
    v_lshl_add_u32 v147, v3, 4, v4
    s_mul_i32 s43, s28, 458752
    s_lshl_b32 s30, s44, 7
    s_add_u32 s43, s43, s30
    s_add_u32 s43, s43, 12582912
    s_lshl_b32 s30, s28, 7
    s_add_u32 s30, s30, 158336
    v_lshl_add_u32 v150, v1, 4, s30
    v_and_b32 v2, 31, v1
    v_lshlrev_b32 v3, 2, v2
    v_add_u32 v151, 158336, v3
    v_lshrrev_b32 v5, 2, v2
    v_bfe_u32 v6, v2, 1, 1
    v_lshl_add_u32 v156, v5, 1, v6
    v_mov_b32 v154, 0
    v_mov_b32 v155, 0
    s_barrier
L_moe_all:
    s_cmp_ge_u32 s34, 224
    s_cbranch_scc1 L_moe_red
    ds_read_b64 v[16:17], v144 offset:0
    ds_read_b64 v[18:19], v144 offset:32
    ds_read_b64 v[20:21], v144 offset:64
    ds_read_b64 v[22:23], v144 offset:96
    ds_read_b64 v[24:25], v144 offset:128
    ds_read_b64 v[26:27], v144 offset:160
    ds_read_b64 v[28:29], v144 offset:192
    ds_read_b64 v[30:31], v144 offset:224
    ds_read_b64 v[32:33], v144 offset:256
    ds_read_b64 v[34:35], v144 offset:288
    ds_read_b64 v[36:37], v144 offset:320
    ds_read_b64 v[38:39], v144 offset:352
    ds_read_b64 v[40:41], v144 offset:384
    ds_read_b64 v[42:43], v144 offset:416
    v_and_b32 v3, 15, v1
    v_cmp_gt_u32 s[52:53], 2, v3
    s_waitcnt lgkmcnt(6)
    ds_read_b64 v[44:45], v144 offset:448
    ds_read_b64 v[46:47], v144 offset:480
    v_mfma_f32_16x16x32_bf16 v[8:11], v[160:163], v[16:19], 0
    v_mfma_f32_16x16x32_bf16 v[8:11], v[164:167], v[20:23], v[8:11]
    v_mfma_f32_16x16x32_bf16 v[8:11], v[168:171], v[24:27], v[8:11]
    v_mfma_f32_16x16x32_bf16 v[8:11], v[172:175], v[28:31], v[8:11]
    s_waitcnt lgkmcnt(0)
    v_mfma_f32_16x16x32_bf16 v[8:11], v[176:179], v[32:35], v[8:11]
    v_mfma_f32_16x16x32_bf16 v[8:11], v[180:183], v[36:39], v[8:11]
    v_mfma_f32_16x16x32_bf16 v[8:11], v[184:187], v[40:43], v[8:11]
    v_mfma_f32_16x16x32_bf16 v[8:11], v[188:191], v[44:47], v[8:11]
    s_mov_b64 s[46:47], exec
    s_mov_b64 exec, s[52:53]
    s_nop 5
    buffer_store_dwordx4 v[8:11], v145, s[12:15], s40 offen sc1
    s_mov_b64 exec, s[46:47]
    s_cmp_lg_u32 s28, 4
    s_cbranch_scc1 L_moe_hm
    s_mov_b32 s33, 400000
L_pre_42:
    buffer_load_dwordx4 v[16:19], v146, s[12:15], s41 offen sc1
    s_waitcnt vmcnt(0)
    v_max_u32 v44, v16, v17
    v_max3_u32 v44, v18, v19, v44
    v_cmp_eq_u32 vcc, -1, v44
    s_cmp_eq_u64 vcc, 0
    s_cbranch_scc1 L_pre_42_ok
    s_sleep 1
    s_sub_u32 s33, s33, 1
    s_cmp_lg_u32 s33, 0
    s_cbranch_scc1 L_pre_42
    s_mov_b32 s54, 9
L_pre_42_ok:
    v_mov_b32 v20, v16
    v_mov_b32 v21, v17
    v_mov_b32 v22, v18
    v_mov_b32 v23, v19
    s_nop 0
    v_permlane16_swap_b32 v20, v16
    v_permlane16_swap_b32 v21, v17
    v_permlane16_swap_b32 v22, v18
    v_permlane16_swap_b32 v23, v19
    v_add_f32 v16, v16, v20
    v_add_f32 v17, v17, v21
    v_add_f32 v18, v18, v22
    v_add_f32 v19, v19, v23
    v_mov_b32 v20, v16
    v_mov_b32 v21, v17
    v_mov_b32 v22, v18
    v_mov_b32 v23, v19
    s_nop 0
    v_permlane32_swap_b32 v20, v16
    v_permlane32_swap_b32 v21, v17
    v_permlane32_swap_b32 v22, v18
    v_permlane32_swap_b32 v23, v19
    v_add_f32 v16, v16, v20
    v_add_f32 v17, v17, v21
    v_add_f32 v18, v18, v22
    v_add_f32 v19, v19, v23
    v_mul_f32 v24, 0xbfb8aa3b, v16
    v_mul_f32 v25, 0xbfb8aa3b, v17
    v_mul_f32 v26, 0xbfb8aa3b, v18
    v_mul_f32 v27, 0xbfb8aa3b, v19
    v_mov_b32_dpp v20, v16 row_ror:8 row_mask:0xf bank_mask:0xf
    v_mov_b32_dpp v21, v17 row_ror:8 row_mask:0xf bank_mask:0xf
    v_mov_b32_dpp v22, v18 row_ror:8 row_mask:0xf bank_mask:0xf
    v_mov_b32_dpp v23, v19 row_ror:8 row_mask:0xf bank_mask:0xf
    v_exp_f32 v24, v24
    v_exp_f32 v25, v25
    v_exp_f32 v26, v26
    v_exp_f32 v27, v27
    v_add_f32 v24, 1.0, v24
    v_add_f32 v25, 1.0, v25
    v_add_f32 v26, 1.0, v26
    v_add_f32 v27, 1.0, v27
    v_rcp_f32 v24, v24
    v_rcp_f32 v25, v25
    v_rcp_f32 v26, v26
    v_rcp_f32 v27, v27
    v_mul_f32 v16, v16, v20
    v_mul_f32 v17, v17, v21
    v_mul_f32 v18, v18, v22
    v_mul_f32 v19, v19, v23
    v_mul_f32 v16, v16, v24
    v_mul_f32 v17, v17, v25
    v_mul_f32 v18, v18, v26
    v_mul_f32 v19, v19, v27
    s_mov_b64 s[46:47], exec
    s_mov_b64 exec, 0xff
    ds_write_b32 v149, v16 offset:0
    ds_write_b32 v149, v17 offset:8
    ds_write_b32 v149, v18 offset:16
    ds_write_b32 v149, v19 offset:24
    s_mov_b64 exec, s[46:47]
    s_waitcnt lgkmcnt(0)
L_moe_hm:
    v_mov_b32 v3, 159360
    s_barrier
    ds_read_b128 v[24:27], v3 offset:0
    ds_read_b128 v[28:31], v3 offset:16
    ds_read_b128 v[32:35], v3 offset:32
    ds_read_b128 v[36:39], v3 offset:48
    ds_read_b128 v[40:43], v3 offset:64
    ds_read_b128 v[44:47], v3 offset:80
    ds_read_b128 v[48:51], v3 offset:96
    ds_read_b128 v[52:55], v3 offset:112
    s_waitcnt lgkmcnt(6)
    v_pk_mul_f32 v[8:9], v[96:97], v[24:25] op_sel_hi:[0,1]
    v_pk_mul_f32 v[10:11], v[96:97], v[24:25] op_sel:[1,0] op_sel_hi:[1,1]
    v_pk_fma_f32 v[8:9], v[98:99], v[26:27], v[8:9] op_sel_hi:[0,1,1]
    v_pk_fma_f32 v[10:11], v[98:99], v[26:27], v[10:11] op_sel:[1,0,0] op_sel_hi:[1,1,1]
    v_pk_fma_f32 v[8:9], v[100:101], v[28:29], v[8:9] op_sel_hi:[0,1,1]
    v_pk_fma_f32 v[10:11], v[100:101], v[28:29], v[10:11] op_sel:[1,0,0] op_sel_hi:[1,1,1]
    v_pk_fma_f32 v[8:9], v[102:103], v[30:31], v[8:9] op_sel_hi:[0,1,1]
    v_pk_fma_f32 v[10:11], v[102:103], v[30:31], v[10:11] op_sel:[1,0,0] op_sel_hi:[1,1,1]
    s_waitcnt lgkmcnt(4)
    v_pk_fma_f32 v[8:9], v[104:105], v[32:33], v[8:9] op_sel_hi:[0,1,1]
    v_pk_fma_f32 v[10:11], v[104:105], v[32:33], v[10:11] op_sel:[1,0,0] op_sel_hi:[1,1,1]
    v_pk_fma_f32 v[8:9], v[106:107], v[34:35], v[8:9] op_sel_hi:[0,1,1]
    v_pk_fma_f32 v[10:11], v[106:107], v[34:35], v[10:11] op_sel:[1,0,0] op_sel_hi:[1,1,1]
    v_pk_fma_f32 v[8:9], v[108:109], v[36:37], v[8:9] op_sel_hi:[0,1,1]
    v_pk_fma_f32 v[10:11], v[108:109], v[36:37], v[10:11] op_sel:[1,0,0] op_sel_hi:[1,1,1]
    v_pk_fma_f32 v[8:9], v[110:111], v[38:39], v[8:9] op_sel_hi:[0,1,1]
    v_pk_fma_f32 v[10:11], v[110:111], v[38:39], v[10:11] op_sel:[1,0,0] op_sel_hi:[1,1,1]
    s_waitcnt lgkmcnt(2)
    v_pk_fma_f32 v[8:9], v[112:113], v[40:41], v[8:9] op_sel_hi:[0,1,1]
    v_pk_fma_f32 v[10:11], v[112:113], v[40:41], v[10:11] op_sel:[1,0,0] op_sel_hi:[1,1,1]
    v_pk_fma_f32 v[8:9], v[114:115], v[42:43], v[8:9] op_sel_hi:[0,1,1]
    v_pk_fma_f32 v[10:11], v[114:115], v[42:43], v[10:11] op_sel:[1,0,0] op_sel_hi:[1,1,1]
    v_pk_fma_f32 v[8:9], v[116:117], v[44:45], v[8:9] op_sel_hi:[0,1,1]
    v_pk_fma_f32 v[10:11], v[116:117], v[44:45], v[10:11] op_sel:[1,0,0] op_sel_hi:[1,1,1]
    v_pk_fma_f32 v[8:9], v[118:119], v[46:47], v[8:9] op_sel_hi:[0,1,1]
    v_pk_fma_f32 v[10:11], v[118:119], v[46:47], v[10:11] op_sel:[1,0,0] op_sel_hi:[1,1,1]
    s_waitcnt lgkmcnt(0)
    v_pk_fma_f32 v[8:9], v[120:121], v[48:49], v[8:9] op_sel_hi:[0,1,1]
    v_pk_fma_f32 v[10:11], v[120:121], v[48:49], v[10:11] op_sel:[1,0,0] op_sel_hi:[1,1,1]
    v_pk_fma_f32 v[8:9], v[122:123], v[50:51], v[8:9] op_sel_hi:[0,1,1]
    v_pk_fma_f32 v[10:11], v[122:123], v[50:51], v[10:11] op_sel:[1,0,0] op_sel_hi:[1,1,1]
    v_pk_fma_f32 v[8:9], v[124:125], v[52:53], v[8:9] op_sel_hi:[0,1,1]
    v_pk_fma_f32 v[10:11], v[124:125], v[52:53], v[10:11] op_sel:[1,0,0] op_sel_hi:[1,1,1]
    v_pk_fma_f32 v[8:9], v[126:127], v[54:55], v[8:9] op_sel_hi:[0,1,1]
    v_pk_fma_f32 v[10:11], v[126:127], v[54:55], v[10:11] op_sel:[1,0,0] op_sel_hi:[1,1,1]
    buffer_store_dwordx4 v[8:11], v148, s[12:15], s42 offen sc1
L_moe_red:
    v_mov_b32 v3, 152064
    ds_read_b128 v[4:7], v3 offset:16
    ds_read_b64 v[8:9], v3 offset:32
    s_waitcnt lgkmcnt(0)
    v_readfirstlane_b32 s98, v4
    v_readfirstlane_b32 s99, v5
    v_readfirstlane_b32 s100, v6
    v_readfirstlane_b32 s101, v7
    v_readfirstlane_b32 s55, v8
    v_readfirstlane_b32 s56, v9
    s_cmp_ge_u32 s28, 4
    s_cbranch_scc1 L_nodef_43
    s_lshl_b32 s30, s58, 6
    v_add_u32 v2, s30, v137
    v_cmp_eq_u32 vcc, s62, v137
    v_cmp_eq_u32 s[52:53], s63, v137
    s_or_b64 vcc, vcc, s[52:53]
    v_cmp_ne_u32 s[52:53], s98, v2
    s_and_b64 vcc, vcc, s[52:53]
    v_cmp_ne_u32 s[52:53], s99, v2
    s_and_b64 vcc, vcc, s[52:53]
    s_and_saveexec_b64 s[46:47], vcc
    s_cbranch_execz L_def_44
    buffer_store_dwordx4 v[192:195], v136, s[16:19], s49 offen nt
    buffer_store_dwordx4 v[196:199], v136, s[16:19], s49 offen offset:32 nt
L_def_44:
    s_mov_b64 exec, s[46:47]
    s_lshl_b32 s30, s58, 6
    v_add_u32 v2, s30, v138
    v_cmp_eq_u32 vcc, s62, v138
    v_cmp_eq_u32 s[52:53], s63, v138
    s_or_b64 vcc, vcc, s[52:53]
    v_cmp_ne_u32 s[52:53], s98, v2
    s_and_b64 vcc, vcc, s[52:53]
    v_cmp_ne_u32 s[52:53], s99, v2
    s_and_b64 vcc, vcc, s[52:53]
    s_and_saveexec_b64 s[46:47], vcc
    s_cbranch_execz L_def_45
    buffer_store_dwordx4 v[200:203], v136, s[16:19], s50 offen nt
    buffer_store_dwordx4 v[204:207], v136, s[16:19], s50 offen offset:32 nt
L_def_45:
    s_mov_b64 exec, s[46:47]
L_nodef_43:
    s_and_b32 s30, s34, 3
    s_cmp_lg_u32 s30, 0
    s_cbranch_scc1 L_fin
    s_cmp_lg_u32 s28, 0
    s_cbranch_scc1 L_nobase_46
    v_and_b32 v4, 1, v1
    v_cmp_eq_u32 vcc, 0, v4
    v_mov_b32 v16, s56
    v_mov_b32 v17, s55
    v_mov_b32 v18, s101
    v_mov_b32 v19, s100
    v_mov_b32 v20, s99
    v_mov_b32 v21, s98
    v_cndmask_b32 v16, v16, v17, vcc
    v_cndmask_b32 v18, v18, v19, vcc
    v_cndmask_b32 v20, v20, v21, vcc
    v_and_b32 v17, 31, v16
    v_lshlrev_b32 v17, 17, v17
    v_lshrrev_b32 v16, 5, v16
    v_lshl_add_u32 v17, v16, 9, v17
    v_lshl_add_u32 v155, v156, 2, v17
    s_lshr_b32 s30, s44, 3
    s_lshl_b32 s30, s30, 14
    s_and_b32 s31, s44, 7
    s_lshl_b32 s31, s31, 6
    s_add_u32 s30, s30, s31
    s_add_u32 s49, s30, 12592640
    v_mul_f32 v18, 0xbfb8aa3b, v18
    v_exp_f32 v18, v18
    v_lshlrev_b32 v20, 11, v20
    v_add_f32 v18, 1.0, v18
    v_rcp_f32 v153, v18
    v_lshl_add_u32 v154, v156, 1, v20
    buffer_load_dword v152, v155, s[12:15], s49 offen sc1
L_nobase_46:
    v_mov_b32 v36, 0
    v_mov_b32 v37, 0
    v_mov_b32 v38, 0
    v_mov_b32 v39, 0
    s_mov_b32 s33, 400000
L_yp_47:
    s_add_u32 s30, s43, 0
    buffer_load_dwordx4 v[24:27], v147, s[12:15], s30 offen sc1
    s_add_u32 s30, s43, 131072
    buffer_load_dwordx4 v[28:31], v147, s[12:15], s30 offen sc1
    s_add_u32 s30, s43, 262144
    buffer_load_dwordx4 v[32:35], v147, s[12:15], s30 offen sc1
    s_add_u32 s30, s43, 393216
    s_mov_b32 exec_hi, 0
    buffer_load_dwordx4 v[36:39], v147, s[12:15], s30 offen sc1
    s_mov_b32 exec_hi, -1
    s_waitcnt vmcnt(0)
    v_max_u32 v44, v24, v25
    v_max3_u32 v44, v26, v27, v44
    v_max3_u32 v44, v28, v29, v44
    v_max3_u32 v44, v30, v31, v44
    v_max3_u32 v44, v32, v33, v44
    v_max3_u32 v44, v34, v35, v44
    v_max3_u32 v44, v36, v37, v44
    v_max3_u32 v44, v38, v39, v44
    v_cmp_eq_u32 vcc, -1, v44
    s_cmp_eq_u64 vcc, 0
    s_cbranch_scc1 L_yp_47_ok
    s_sleep 1
    s_sub_u32 s33, s33, 1
    s_cmp_lg_u32 s33, 0
    s_cbranch_scc1 L_yp_47
    s_mov_b32 s54, 7
L_yp_47_ok:
    v_pk_add_f32 v[24:25], v[24:25], v[28:29]
    v_pk_add_f32 v[26:27], v[26:27], v[30:31]
    v_pk_add_f32 v[24:25], v[24:25], v[32:33]
    v_pk_add_f32 v[26:27], v[26:27], v[34:35]
    v_pk_add_f32 v[24:25], v[24:25], v[36:37]
    v_pk_add_f32 v[26:27], v[26:27], v[38:39]
    s_nop 1
    v_add_f32_dpp v24, v24, v24 row_ror:8 row_mask:0xf bank_mask:0xf
    v_add_f32_dpp v25, v25, v25 row_ror:8 row_mask:0xf bank_mask:0xf
    v_add_f32_dpp v26, v26, v26 row_ror:8 row_mask:0xf bank_mask:0xf
    v_add_f32_dpp v27, v27, v27 row_ror:8 row_mask:0xf bank_mask:0xf
    v_mov_b32 v28, v24
    v_mov_b32 v29, v25
    v_mov_b32 v30, v26
    v_mov_b32 v31, v27
    s_nop 0
    v_permlane16_swap_b32 v28, v24
    v_permlane16_swap_b32 v29, v25
    v_permlane16_swap_b32 v30, v26
    v_permlane16_swap_b32 v31, v27
    v_add_f32 v24, v24, v28
    v_add_f32 v25, v25, v29
    v_add_f32 v26, v26, v30
    v_add_f32 v27, v27, v31
    v_mov_b32 v28, v24
    v_mov_b32 v29, v25
    v_mov_b32 v30, v26
    v_mov_b32 v31, v27
    s_nop 0
    v_permlane32_swap_b32 v28, v24
    v_permlane32_swap_b32 v29, v25
    v_permlane32_swap_b32 v30, v26
    v_permlane32_swap_b32 v31, v27
    v_add_f32 v24, v24, v28
    v_add_f32 v25, v25, v29
    v_add_f32 v26, v26, v30
    v_add_f32 v27, v27, v31
    s_mov_b64 s[46:47], exec
    s_mov_b64 exec, 0xff
    ds_write_b128 v150, v[24:27]
    s_mov_b64 exec, s[46:47]
    s_waitcnt lgkmcnt(0)
    s_barrier
    s_cmp_lg_u32 s28, 0
    s_cbranch_scc1 L_fin
    ds_read_b32 v8, v151 offset:0
    ds_read_b32 v9, v151 offset:128
    ds_read_b32 v10, v151 offset:256
    ds_read_b32 v11, v151 offset:384
    ds_read_b32 v12, v151 offset:512
    ds_read_b32 v13, v151 offset:640
    ds_read_b32 v14, v151 offset:768
    ds_read_b32 v15, v151 offset:896
    v_cmp_eq_u32 vcc, -1, v152
    s_cmp_eq_u64 vcc, 0
    s_cbranch_scc1 L_baseok_48
    s_mov_b32 s33, 400000
L_base_49:
    buffer_load_dword v152, v155, s[12:15], s49 offen sc1
    v_mov_b32 v23, 0
    s_waitcnt vmcnt(0)
    v_max_u32 v44, v152, v23
    v_cmp_eq_u32 vcc, -1, v44
    s_cmp_eq_u64 vcc, 0
    s_cbranch_scc1 L_base_49_ok
    s_sleep 1
    s_sub_u32 s33, s33, 1
    s_cmp_lg_u32 s33, 0
    s_cbranch_scc1 L_base_49
    s_mov_b32 s54, 8
L_base_49_ok:
L_baseok_48:
    s_lshl_b32 s30, s44, 5
    s_waitcnt lgkmcnt(0)
    v_add_f32 v8, v8, v9
    v_add_f32 v10, v10, v11
    v_add_f32 v12, v12, v13
    v_add_f32 v14, v14, v15
    v_add_f32 v8, v8, v10
    v_add_f32 v12, v12, v14
    v_add_f32 v8, v8, v12
    v_fma_f32 v8, v8, v153, v152
    v_cvt_pk_bf16_f32 v8, v8, v8
    s_mov_b32 exec_hi, 0
    buffer_store_short v8, v154, s[16:19], s30 offen
    s_branch L_fin
L_g2_loader:
    v_lshrrev_b32 v2, 4, v1
    v_and_b32 v3, 15, v1
    v_lshlrev_b32 v4, 2, v2
    v_xor_b32 v3, v3, v4
    v_lshlrev_b32 v3, 4, v3
    v_lshl_add_u32 v3, v2, 11, v3
    v_lshlrev_b32 v16, 4, v1
    v_add_u32 v8, 0, v3
    v_add_u32 v9, 7168, v3
    v_add_u32 v10, 14336, v3
    v_add_u32 v11, 21504, v3
    v_add_u32 v12, 32768, v3
    v_add_u32 v13, 39936, v3
    v_add_u32 v14, 47104, v3
    v_add_u32 v15, 54272, v3
    s_mul_i32 s36, s29, 65536
    s_lshl_b32 s30, s59, 8
    s_add_u32 s36, s36, s30
    s_lshr_b32 s30, s29, 1
    s_and_b32 s31, s29, 1
    s_lshl_b32 s32, s58, 1
    s_add_u32 s32, s32, s30
    s_lshl_b32 s32, s32, 5
    s_mul_i32 s33, s31, 2
    s_add_u32 s32, s32, s33
    s_lshl_b32 s35, s32, 11
    s_add_u32 s35, s35, 8388608
    s_mul_i32 s30, s30, 8192
    s_mul_i32 s31, s31, 4096
    s_add_u32 s30, s30, s31
    s_mul_i32 s31, s29, 8192
    s_add_u32 s40, s30, 0
    s_add_u32 s43, s31, 16384
    s_add_u32 s41, s30, 49152
    s_add_u32 s44, s31, 65536
    s_add_u32 s42, s30, 98304
    s_add_u32 s45, s31, 114688
    s_mov_b32 m0, s43
    s_nop 0
    buffer_load_dwordx4 v8, s[8:11], s36 offen lds
    buffer_load_dwordx4 v9, s[8:11], s36 offen offset:1024 lds
    buffer_load_dwordx4 v10, s[8:11], s36 offen offset:2048 lds
    buffer_load_dwordx4 v11, s[8:11], s36 offen offset:3072 lds
    s_add_u32 m0, m0, 0x1000
    s_nop 0
    buffer_load_dwordx4 v12, s[8:11], s36 offen lds
    buffer_load_dwordx4 v13, s[8:11], s36 offen offset:1024 lds
    buffer_load_dwordx4 v14, s[8:11], s36 offen offset:2048 lds
    buffer_load_dwordx4 v15, s[8:11], s36 offen offset:3072 lds
    s_add_u32 s36, s36, 262144
    s_mov_b32 m0, s44
    s_nop 0
    buffer_load_dwordx4 v8, s[8:11], s36 offen lds
    buffer_load_dwordx4 v9, s[8:11], s36 offen offset:1024 lds
    buffer_load_dwordx4 v10, s[8:11], s36 offen offset:2048 lds
    buffer_load_dwordx4 v11, s[8:11], s36 offen offset:3072 lds
    s_add_u32 m0, m0, 0x1000
    s_nop 0
    buffer_load_dwordx4 v12, s[8:11], s36 offen lds
    buffer_load_dwordx4 v13, s[8:11], s36 offen offset:1024 lds
    buffer_load_dwordx4 v14, s[8:11], s36 offen offset:2048 lds
    buffer_load_dwordx4 v15, s[8:11], s36 offen offset:3072 lds
    s_add_u32 s36, s36, 262144
    s_mov_b32 m0, s45
    s_nop 0
    buffer_load_dwordx4 v8, s[8:11], s36 offen lds
    buffer_load_dwordx4 v9, s[8:11], s36 offen offset:1024 lds
    buffer_load_dwordx4 v10, s[8:11], s36 offen offset:2048 lds
    buffer_load_dwordx4 v11, s[8:11], s36 offen offset:3072 lds
    s_add_u32 m0, m0, 0x1000
    s_nop 0
    buffer_load_dwordx4 v12, s[8:11], s36 offen lds
    buffer_load_dwordx4 v13, s[8:11], s36 offen offset:1024 lds
    buffer_load_dwordx4 v14, s[8:11], s36 offen offset:2048 lds
    buffer_load_dwordx4 v15, s[8:11], s36 offen offset:3072 lds
    s_add_u32 s36, s36, 262144
    s_lshl_b32 s30, s29, 6
    v_add_u32 v2, s30, v1
    v_lshlrev_b32 v2, 14, v2
    s_mov_b32 s30, 12595072
    s_mov_b32 s33, 400000
L_rdy_50:
    buffer_load_dword v3, v2, s[12:15], s30 offen sc1
    s_waitcnt vmcnt(0)
    v_cmp_ne_u32 vcc, s3, v3
    s_cmp_eq_u64 vcc, 0
    s_cbranch_scc1 L_rdy_50_ok
    s_sleep 2
    s_sub_u32 s33, s33, 1
    s_cmp_lg_u32 s33, 0
    s_cbranch_scc1 L_rdy_50
    s_mov_b32 s54, 10
L_rdy_50_ok:
    s_barrier
    s_mov_b32 m0, s40
    s_nop 0
    buffer_load_dwordx4 v16, s[12:15], s35 offen sc1 lds
    buffer_load_dwordx4 v16, s[12:15], s35 offen offset:1024 sc1 lds
    buffer_load_dwordx4 v16, s[12:15], s35 offen offset:2048 sc1 lds
    buffer_load_dwordx4 v16, s[12:15], s35 offen offset:3072 sc1 lds
    s_add_u32 s35, s35, 8192
    s_mov_b32 m0, s41
    s_nop 0
    buffer_load_dwordx4 v16, s[12:15], s35 offen sc1 lds
    buffer_load_dwordx4 v16, s[12:15], s35 offen offset:1024 sc1 lds
    buffer_load_dwordx4 v16, s[12:15], s35 offen offset:2048 sc1 lds
    buffer_load_dwordx4 v16, s[12:15], s35 offen offset:3072 sc1 lds
    s_add_u32 s35, s35, 8192
    s_mov_b32 m0, s42
    s_nop 0
    buffer_load_dwordx4 v16, s[12:15], s35 offen sc1 lds
    buffer_load_dwordx4 v16, s[12:15], s35 offen offset:1024 sc1 lds
    buffer_load_dwordx4 v16, s[12:15], s35 offen offset:2048 sc1 lds
    buffer_load_dwordx4 v16, s[12:15], s35 offen offset:3072 sc1 lds
    s_add_u32 s35, s35, 8192
    s_lshl_b32 s30, s58, 17
    s_and_b32 s31, s59, 3
    s_lshl_b32 s31, s31, 15
    s_add_u32 s30, s30, s31
    s_lshl_b32 s31, s29, 13
    s_add_u32 s30, s30, s31
    s_add_u32 s30, s30, 8388608
    v_lshlrev_b32 v2, 7, v1
    buffer_load_dword v255, v2, s[12:15], s30 offen sc1
    s_waitcnt vmcnt(9)
    s_barrier
    s_waitcnt vmcnt(5)
    s_barrier
    s_mov_b32 m0, s40
    s_nop 0
    buffer_load_dwordx4 v16, s[12:15], s35 offen sc1 lds
    buffer_load_dwordx4 v16, s[12:15], s35 offen offset:1024 sc1 lds
    buffer_load_dwordx4 v16, s[12:15], s35 offen offset:2048 sc1 lds
    buffer_load_dwordx4 v16, s[12:15], s35 offen offset:3072 sc1 lds
    s_add_u32 s35, s35, 8192
    s_mov_b32 m0, s43
    s_nop 0
    buffer_load_dwordx4 v8, s[8:11], s36 offen lds
    buffer_load_dwordx4 v9, s[8:11], s36 offen offset:1024 lds
    buffer_load_dwordx4 v10, s[8:11], s36 offen offset:2048 lds
    buffer_load_dwordx4 v11, s[8:11], s36 offen offset:3072 lds
    s_add_u32 m0, m0, 0x1000
    s_nop 0
    buffer_load_dwordx4 v12, s[8:11], s36 offen lds
    buffer_load_dwordx4 v13, s[8:11], s36 offen offset:1024 lds
    buffer_load_dwordx4 v14, s[8:11], s36 offen offset:2048 lds
    buffer_load_dwordx4 v15, s[8:11], s36 offen offset:3072 lds
    s_add_u32 s36, s36, 262144
    s_waitcnt vmcnt(13)
    s_barrier
    s_mov_b32 m0, s41
    s_nop 0
    buffer_load_dwordx4 v16, s[12:15], s35 offen sc1 lds
    buffer_load_dwordx4 v16, s[12:15], s35 offen offset:1024 sc1 lds
    buffer_load_dwordx4 v16, s[12:15], s35 offen offset:2048 sc1 lds
    buffer_load_dwordx4 v16, s[12:15], s35 offen offset:3072 sc1 lds
    s_add_u32 s35, s35, 8192
    s_mov_b32 m0, s44
    s_nop 0
    buffer_load_dwordx4 v8, s[8:11], s36 offen lds
    buffer_load_dwordx4 v9, s[8:11], s36 offen offset:1024 lds
    buffer_load_dwordx4 v10, s[8:11], s36 offen offset:2048 lds
    buffer_load_dwordx4 v11, s[8:11], s36 offen offset:3072 lds
    s_add_u32 m0, m0, 0x1000
    s_nop 0
    buffer_load_dwordx4 v12, s[8:11], s36 offen lds
    buffer_load_dwordx4 v13, s[8:11], s36 offen offset:1024 lds
    buffer_load_dwordx4 v14, s[8:11], s36 offen offset:2048 lds
    buffer_load_dwordx4 v15, s[8:11], s36 offen offset:3072 lds
    s_add_u32 s36, s36, 262144
    s_waitcnt vmcnt(12)
    s_barrier
    s_mov_b32 m0, s42
    s_nop 0
    buffer_load_dwordx4 v16, s[12:15], s35 offen sc1 lds
    buffer_load_dwordx4 v16, s[12:15], s35 offen offset:1024 sc1 lds
    buffer_load_dwordx4 v16, s[12:15], s35 offen offset:2048 sc1 lds
    buffer_load_dwordx4 v16, s[12:15], s35 offen offset:3072 sc1 lds
    s_add_u32 s35, s35, 8192
    s_mov_b32 m0, s45
    s_nop 0
    buffer_load_dwordx4 v8, s[8:11], s36 offen lds
    buffer_load_dwordx4 v9, s[8:11], s36 offen offset:1024 lds
    buffer_load_dwordx4 v10, s[8:11], s36 offen offset:2048 lds
    buffer_load_dwordx4 v11, s[8:11], s36 offen offset:3072 lds
    s_add_u32 m0, m0, 0x1000
    s_nop 0
    buffer_load_dwordx4 v12, s[8:11], s36 offen lds
    buffer_load_dwordx4 v13, s[8:11], s36 offen offset:1024 lds
    buffer_load_dwordx4 v14, s[8:11], s36 offen offset:2048 lds
    buffer_load_dwordx4 v15, s[8:11], s36 offen offset:3072 lds
    s_add_u32 s36, s36, 262144
    s_waitcnt vmcnt(12)
    s_barrier
    s_mov_b32 m0, s40
    s_nop 0
    buffer_load_dwordx4 v16, s[12:15], s35 offen sc1 lds
    buffer_load_dwordx4 v16, s[12:15], s35 offen offset:1024 sc1 lds
    buffer_load_dwordx4 v16, s[12:15], s35 offen offset:2048 sc1 lds
    buffer_load_dwordx4 v16, s[12:15], s35 offen offset:3072 sc1 lds
    s_add_u32 s35, s35, 8192
    s_mov_b32 m0, s43
    s_nop 0
    buffer_load_dwordx4 v8, s[8:11], s36 offen lds
    buffer_load_dwordx4 v9, s[8:11], s36 offen offset:1024 lds
    buffer_load_dwordx4 v10, s[8:11], s36 offen offset:2048 lds
    buffer_load_dwordx4 v11, s[8:11], s36 offen offset:3072 lds
    s_add_u32 m0, m0, 0x1000
    s_nop 0
    buffer_load_dwordx4 v12, s[8:11], s36 offen lds
    buffer_load_dwordx4 v13, s[8:11], s36 offen offset:1024 lds
    buffer_load_dwordx4 v14, s[8:11], s36 offen offset:2048 lds
    buffer_load_dwordx4 v15, s[8:11], s36 offen offset:3072 lds
    s_add_u32 s36, s36, 262144
    s_waitcnt vmcnt(12)
    s_barrier
    s_mov_b32 m0, s41
    s_nop 0
    buffer_load_dwordx4 v16, s[12:15], s35 offen sc1 lds
    buffer_load_dwordx4 v16, s[12:15], s35 offen offset:1024 sc1 lds
    buffer_load_dwordx4 v16, s[12:15], s35 offen offset:2048 sc1 lds
    buffer_load_dwordx4 v16, s[12:15], s35 offen offset:3072 sc1 lds
    s_add_u32 s35, s35, 8192
    s_mov_b32 m0, s44
    s_nop 0
    buffer_load_dwordx4 v8, s[8:11], s36 offen lds
    buffer_load_dwordx4 v9, s[8:11], s36 offen offset:1024 lds
    buffer_load_dwordx4 v10, s[8:11], s36 offen offset:2048 lds
    buffer_load_dwordx4 v11, s[8:11], s36 offen offset:3072 lds
    s_add_u32 m0, m0, 0x1000
    s_nop 0
    buffer_load_dwordx4 v12, s[8:11], s36 offen lds
    buffer_load_dwordx4 v13, s[8:11], s36 offen offset:1024 lds
    buffer_load_dwordx4 v14, s[8:11], s36 offen offset:2048 lds
    buffer_load_dwordx4 v15, s[8:11], s36 offen offset:3072 lds
    s_add_u32 s36, s36, 262144
    s_waitcnt vmcnt(12)
    s_barrier
    s_waitcnt vmcnt(0)
    s_load_dwordx2 s[20:21], s[0:1], 56
    s_mov_b32 s22, 7340032
    s_mov_b32 s23, 0x20000
    s_min_u32 s30, s34, 223
    s_lshl_b32 s30, s30, 15
    s_lshl_b32 s31, s29, 13
    s_add_u32 s30, s30, s31
    s_add_u32 s31, s31, 98304
    s_mov_b32 m0, s31
    s_waitcnt lgkmcnt(0)
    buffer_load_dwordx4 v16, s[20:23], s30 offen nt lds
    buffer_load_dwordx4 v16, s[20:23], s30 offen offset:1024 nt lds
    buffer_load_dwordx4 v16, s[20:23], s30 offen offset:2048 nt lds
    buffer_load_dwordx4 v16, s[20:23], s30 offen offset:3072 nt lds
    s_add_u32 m0, m0, 0x1000
    s_add_u32 s30, s30, 4096
    buffer_load_dwordx4 v16, s[20:23], s30 offen nt lds
    buffer_load_dwordx4 v16, s[20:23], s30 offen offset:1024 nt lds
    buffer_load_dwordx4 v16, s[20:23], s30 offen offset:2048 nt lds
    buffer_load_dwordx4 v16, s[20:23], s30 offen offset:3072 nt lds
    s_barrier
    s_waitcnt vmcnt(0)
    v_lshrrev_b32 v2, 4, v1
    v_and_b32 v5, 1, v1
    v_lshlrev_b32 v5, 11, v5
    v_lshl_add_u32 v5, v2, 3, v5
    s_and_b32 s30, s34, 3
    s_lshl_b32 s31, s30, 9
    s_add_u32 s31, s31, 152192
    v_add_u32 v144, s31, v5
    v_and_b32 v3, 15, v1
    v_lshlrev_b32 v6, 6, v3
    v_lshl_add_u32 v145, v2, 4, v6
    s_lshl_b32 s42, s34, 14
    s_xor_b32 s31, s28, 4
    s_lshl_b32 s31, s31, 7
    s_add_u32 s40, s42, s31
    s_add_u32 s40, s40, 12594048
    s_add_u32 s42, s42, 12582912
    v_lshlrev_b32 v148, 4, v0
    v_lshlrev_b32 v6, 14, v2
    v_bfe_u32 v3, v1, 3, 1
    v_lshl_add_u32 v6, v3, 9, v6
    v_and_b32 v3, 7, v1
    v_lshl_add_u32 v146, v3, 4, v6
    s_lshl_b32 s31, s30, 7
    s_andn2_b32 s30, s34, 3
    s_lshl_b32 s30, s30, 14
    s_add_u32 s30, s30, s31
    s_add_u32 s41, s30, 12594048
    v_and_b32 v2, 3, v1
    v_bfe_u32 v3, v1, 2, 1
    v_lshlrev_b32 v2, 5, v2
    v_lshl_add_u32 v2, v3, 2, v2
    v_add_u32 v149, 159360, v2
    s_lshr_b32 s44, s34, 2
    v_lshrrev_b32 v2, 3, v1
    v_and_b32 v3, 7, v1
    v_lshlrev_b32 v4, 14, v2
    v_lshl_add_u32 v147, v3, 4, v4
    s_mul_i32 s43, s28, 458752
    s_lshl_b32 s30, s44, 7
    s_add_u32 s43, s43, s30
    s_add_u32 s43, s43, 12582912
    s_lshl_b32 s30, s28, 7
    s_add_u32 s30, s30, 158336
    v_lshl_add_u32 v150, v1, 4, s30
    v_and_b32 v2, 31, v1
    v_lshlrev_b32 v3, 2, v2
    v_add_u32 v151, 158336, v3
    v_lshrrev_b32 v5, 2, v2
    v_bfe_u32 v6, v2, 1, 1
    v_lshl_add_u32 v156, v5, 1, v6
    v_mov_b32 v154, 0
    v_mov_b32 v155, 0
    s_barrier
    s_cmp_lg_u32 s28, 4
    s_cbranch_scc1 L_stage
    v_lshrrev_b32 v2, 5, v1
    v_and_b32 v3, 31, v1
    v_lshlrev_b32 v2, 11, v2
    v_lshl_add_u32 v2, v3, 4, v2
    v_add_u32 v2, 147456, v2
    ds_read_b128 v[24:27], v2 offset:0
    ds_read_b128 v[28:31], v2 offset:512
    ds_read_b128 v[32:35], v2 offset:1024
    ds_read_b128 v[36:39], v2 offset:1536
    s_waitcnt lgkmcnt(0)
    s_mov_b32 s31, 0x3d000000
    v_add_f32 v40, v24, v28
    v_add_f32 v40, v40, v32
    v_add_f32 v40, v40, v36
    v_add_f32 v41, v25, v29
    v_add_f32 v41, v41, v33
    v_add_f32 v41, v41, v37
    v_add_f32 v42, v26, v30
    v_add_f32 v42, v42, v34
    v_add_f32 v42, v42, v38
    v_add_f32 v43, v27, v31
    v_add_f32 v43, v43, v35
    v_add_f32 v43, v43, v39
    v_mul_f32 v44, 0xbc000000, v40
    v_mov_b32 v46, 0
    v_fma_f32 v45, v24, s31, v44
    v_fmac_f32 v46, v45, v45
    v_fma_f32 v45, v28, s31, v44
    v_fmac_f32 v46, v45, v45
    v_fma_f32 v45, v32, s31, v44
    v_fmac_f32 v46, v45, v45
    v_fma_f32 v45, v36, s31, v44
    v_fmac_f32 v46, v45, v45
    v_fmac_f32 v41, 0x42000000, v46
    v_lshlrev_b32 v4, 4, v1
    s_lshl_b32 s30, s34, 14
    s_add_u32 s30, s30, 12591104
    buffer_store_dwordx4 v[40:43], v4, s[12:15], s30 offen sc1
    s_lshl_b32 s48, s58, 17
    s_add_u32 s48, s48, 12591104
    s_mov_b32 s33, 400000
L_pst_51:
    s_mov_b32 s30, s48
    buffer_load_dwordx4 v[48:51], v4, s[12:15], s30 offen sc1
    s_add_u32 s30, s30, 16384
    buffer_load_dwordx4 v[52:55], v4, s[12:15], s30 offen sc1
    s_add_u32 s30, s30, 16384
    buffer_load_dwordx4 v[56:59], v4, s[12:15], s30 offen sc1
    s_add_u32 s30, s30, 16384
    buffer_load_dwordx4 v[60:63], v4, s[12:15], s30 offen sc1
    s_add_u32 s30, s30, 16384
    buffer_load_dwordx4 v[64:67], v4, s[12:15], s30 offen sc1
    s_add_u32 s30, s30, 16384
    buffer_load_dwordx4 v[68:71], v4, s[12:15], s30 offen sc1
    s_add_u32 s30, s30, 16384
    buffer_load_dwordx4 v[72:75], v4, s[12:15], s30 offen sc1
    s_add_u32 s30, s30, 16384
    buffer_load_dwordx4 v[76:79], v4, s[12:15], s30 offen sc1
    s_waitcnt vmcnt(0)
    v_max_u32 v44, v48, v49
    v_max3_u32 v44, v50, v51, v44
    v_max3_u32 v44, v52, v53, v44
    v_max3_u32 v44, v54, v55, v44
    v_max3_u32 v44, v56, v57, v44
    v_max3_u32 v44, v58, v59, v44
    v_max3_u32 v44, v60, v61, v44
    v_max3_u32 v44, v62, v63, v44
    v_max3_u32 v44, v64, v65, v44
    v_max3_u32 v44, v66, v67, v44
    v_max3_u32 v44, v68, v69, v44
    v_max3_u32 v44, v70, v71, v44
    v_max3_u32 v44, v72, v73, v44
    v_max3_u32 v44, v74, v75, v44
    v_max3_u32 v44, v76, v77, v44
    v_max3_u32 v44, v78, v79, v44
    v_cmp_eq_u32 vcc, -1, v44
    s_cmp_eq_u64 vcc, 0
    s_cbranch_scc1 L_pst_51_ok
    s_sleep 1
    s_sub_u32 s33, s33, 1
    s_cmp_lg_u32 s33, 0
    s_cbranch_scc1 L_pst_51
    s_mov_b32 s54, 4
L_pst_51_ok:
    s_mov_b32 s31, 0x3c000000
    v_add_f32 v40, v48, v52
    v_add_f32 v40, v40, v56
    v_add_f32 v40, v40, v60
    v_add_f32 v40, v40, v64
    v_add_f32 v40, v40, v68
    v_add_f32 v40, v40, v72
    v_add_f32 v40, v40, v76
    v_add_f32 v41, v49, v53
    v_add_f32 v41, v41, v57
    v_add_f32 v41, v41, v61
    v_add_f32 v41, v41, v65
    v_add_f32 v41, v41, v69
    v_add_f32 v41, v41, v73
    v_add_f32 v41, v41, v77
    v_add_f32 v42, v50, v54
    v_add_f32 v42, v42, v58
    v_add_f32 v42, v42, v62
    v_add_f32 v42, v42, v66
    v_add_f32 v42, v42, v70
    v_add_f32 v42, v42, v74
    v_add_f32 v42, v42, v78
    v_add_f32 v43, v51, v55
    v_add_f32 v43, v43, v59
    v_add_f32 v43, v43, v63
    v_add_f32 v43, v43, v67
    v_add_f32 v43, v43, v71
    v_add_f32 v43, v43, v75
    v_add_f32 v43, v43, v79
    v_mul_f32 v44, 0xba800000, v40
    v_mov_b32 v46, 0
    v_fma_f32 v45, v48, s31, v44
    v_fmac_f32 v46, v45, v45
    v_fma_f32 v45, v52, s31, v44
    v_fmac_f32 v46, v45, v45
    v_fma_f32 v45, v56, s31, v44
    v_fmac_f32 v46, v45, v45
    v_fma_f32 v45, v60, s31, v44
    v_fmac_f32 v46, v45, v45
    v_fma_f32 v45, v64, s31, v44
    v_fmac_f32 v46, v45, v45
    v_fma_f32 v45, v68, s31, v44
    v_fmac_f32 v46, v45, v45
    v_fma_f32 v45, v72, s31, v44
    v_fmac_f32 v46, v45, v45
    v_fma_f32 v45, v76, s31, v44
    v_fmac_f32 v46, v45, v45
    v_fmac_f32 v41, 0x43000000, v46
    v_mov_b32 v46, 0x3727c5ac
    v_fmac_f32 v46, 0x3a800000, v41
    v_rsq_f32 v46, v46
    v_fma_f32 v47, v44, v43, v42
    v_sub_f32 v45, 0, v44
    v_mul_f32 v47, v47, v46
    v_lshlrev_b32 v2, 2, v1
    v_add_u32 v2, 147456, v2
    ds_write_b32 v2, v45 offset:4096
    ds_write_b32 v2, v46 offset:4352
    v_mov_b32 v48, v47
    s_nop 1
    v_max_f32_dpp v48, v48, v48 quad_perm:[1,0,3,2] row_mask:0xf bank_mask:0xf
    s_nop 1
    v_max_f32_dpp v48, v48, v48 quad_perm:[2,3,0,1] row_mask:0xf bank_mask:0xf
    s_nop 1
    v_max_f32_dpp v48, v48, v48 row_half_mirror row_mask:0xf bank_mask:0xf
    s_nop 1
    v_max_f32_dpp v48, v48, v48 row_mirror row_mask:0xf bank_mask:0xf
    v_mov_b32 v49, v48
    s_nop 1
    v_permlane16_swap_b32 v49, v48
    v_max_f32 v48, v48, v49
    v_mov_b32 v49, v48
    s_nop 1
    v_permlane32_swap_b32 v49, v48
    v_max_f32 v48, v48, v49
    v_cmp_eq_f32 vcc, v48, v47
    v_readfirstlane_b32 s96, v48
    s_ff1_i32_b64 s62, vcc
    s_max_i32 s62, s62, 0
    v_mov_b32 v49, 0xff800000
    v_cmp_eq_u32 vcc, s62, v1
    s_nop 1
    v_cndmask_b32 v47, v47, v49, vcc
    v_mov_b32 v48, v47
    s_nop 1
    v_max_f32_dpp v48, v48, v48 quad_perm:[1,0,3,2] row_mask:0xf bank_mask:0xf
    s_nop 1
    v_max_f32_dpp v48, v48, v48 quad_perm:[2,3,0,1] row_mask:0xf bank_mask:0xf
    s_nop 1
    v_max_f32_dpp v48, v48, v48 row_half_mirror row_mask:0xf bank_mask:0xf
    s_nop 1
    v_max_f32_dpp v48, v48, v48 row_mirror row_mask:0xf bank_mask:0xf
    v_mov_b32 v49, v48
    s_nop 1
    v_permlane16_swap_b32 v49, v48
    v_max_f32 v48, v48, v49
    v_mov_b32 v49, v48
    s_nop 1
    v_permlane32_swap_b32 v49, v48
    v_max_f32 v48, v48, v49
    v_cmp_eq_f32 vcc, v48, v47
    v_readfirstlane_b32 s97, v48
    s_ff1_i32_b64 s63, vcc
    s_max_i32 s63, s63, 0
    v_mov_b32 v4, s62
    v_mov_b32 v5, s63
    v_mov_b32 v2, 152064
    ds_write_b64 v2, v[4:5]
    s_cmp_lg_u32 s59, 0
    s_cbranch_scc1 L_nogr
    s_lshl_b32 s30, s58, 6
    v_mov_b32 v4, s96
    v_add_u32 v5, s30, v4
    s_add_u32 s31, s30, s62
    s_add_u32 s32, s30, s63
    v_mov_b32 v5, s31
    v_mov_b32 v6, s97
    v_mov_b32 v7, s32
    s_lshl_b32 s30, s34, 14
    s_add_u32 s30, s30, 12593664
    v_cmp_eq_u32 vcc, 0, v1
    s_and_saveexec_b64 s[46:47], vcc
    buffer_store_dwordx4 v[4:7], off, s[12:15], s30 sc1
    s_mov_b64 exec, s[46:47]
L_nogr:
    s_waitcnt lgkmcnt(0)
    s_barrier
    v_lshlrev_b32 v2, 2, v0
    v_add_u32 v2, 98304, v2
    ds_read_b32 v232, v2 offset:0
    ds_read_b32 v233, v2 offset:2048
    ds_read_b32 v234, v2 offset:4096
    ds_read_b32 v235, v2 offset:6144
    ds_read_b32 v236, v2 offset:8192
    ds_read_b32 v237, v2 offset:10240
    ds_read_b32 v238, v2 offset:12288
    ds_read_b32 v239, v2 offset:14336
    s_waitcnt lgkmcnt(0)
    ds_read_b32 v240, v2 offset:16384
    ds_read_b32 v241, v2 offset:18432
    ds_read_b32 v242, v2 offset:20480
    ds_read_b32 v243, v2 offset:22528
    ds_read_b32 v244, v2 offset:24576
    ds_read_b32 v245, v2 offset:26624
    ds_read_b32 v246, v2 offset:28672
    ds_read_b32 v247, v2 offset:30720
    s_waitcnt lgkmcnt(0)
    v_lshlrev_b32 v96, 16, v232
    v_and_b32 v97, 0xffff0000, v232
    v_lshlrev_b32 v98, 16, v233
    v_and_b32 v99, 0xffff0000, v233
    v_lshlrev_b32 v100, 16, v234
    v_and_b32 v101, 0xffff0000, v234
    v_lshlrev_b32 v102, 16, v235
    v_and_b32 v103, 0xffff0000, v235
    v_lshlrev_b32 v104, 16, v236
    v_and_b32 v105, 0xffff0000, v236
    v_lshlrev_b32 v106, 16, v237
    v_and_b32 v107, 0xffff0000, v237
    v_lshlrev_b32 v108, 16, v238
    v_and_b32 v109, 0xffff0000, v238
    v_lshlrev_b32 v110, 16, v239
    v_and_b32 v111, 0xffff0000, v239
    v_lshlrev_b32 v112, 16, v240
    v_and_b32 v113, 0xffff0000, v240
    v_lshlrev_b32 v114, 16, v241
    v_and_b32 v115, 0xffff0000, v241
    v_lshlrev_b32 v116, 16, v242
    v_and_b32 v117, 0xffff0000, v242
    v_lshlrev_b32 v118, 16, v243
    v_and_b32 v119, 0xffff0000, v243
    v_lshlrev_b32 v120, 16, v244
    v_and_b32 v121, 0xffff0000, v244
    v_lshlrev_b32 v122, 16, v245
    v_and_b32 v123, 0xffff0000, v245
    v_lshlrev_b32 v124, 16, v246
    v_and_b32 v125, 0xffff0000, v246
    v_lshlrev_b32 v126, 16, v247
    v_and_b32 v127, 0xffff0000, v247
    v_and_b32 v2, 31, v1
    v_lshlrev_b32 v2, 17, v2
    s_mov_b32 s48, 12593664
    s_mov_b32 s33, 400000
L_gr_52:
    buffer_load_dwordx4 v[24:27], v2, s[12:15], s48 offen sc1
    s_waitcnt vmcnt(0)
    v_max_u32 v44, v24, v25
    v_max3_u32 v44, v26, v27, v44
    v_cmp_eq_u32 vcc, -1, v44
    s_cmp_eq_u64 vcc, 0
    s_cbranch_scc1 L_gr_52_ok
    s_sleep 1
    s_sub_u32 s33, s33, 1
    s_cmp_lg_u32 s33, 0
    s_cbranch_scc1 L_gr_52
    s_mov_b32 s54, 5
L_gr_52_ok:
    v_cmp_gt_u32 vcc, 32, v1
    s_nop 1
    v_cndmask_b32 v28, v26, v24, vcc
    v_cndmask_b32 v29, v27, v25, vcc
    v_mov_b32 v30, v28
    s_nop 1
    v_max_f32_dpp v30, v30, v30 quad_perm:[1,0,3,2] row_mask:0xf bank_mask:0xf
    s_nop 1
    v_max_f32_dpp v30, v30, v30 quad_perm:[2,3,0,1] row_mask:0xf bank_mask:0xf
    s_nop 1
    v_max_f32_dpp v30, v30, v30 row_half_mirror row_mask:0xf bank_mask:0xf
    s_nop 1
    v_max_f32_dpp v30, v30, v30 row_mirror row_mask:0xf bank_mask:0xf
    v_mov_b32 v31, v30
    s_nop 1
    v_permlane16_swap_b32 v31, v30
    v_max_f32 v30, v30, v31
    v_mov_b32 v31, v30
    s_nop 1
    v_permlane32_swap_b32 v31, v30
    v_max_f32 v30, v30, v31
    v_cmp_eq_f32 vcc, v30, v28
    v_readfirstlane_b32 s100, v30
    s_ff1_i32_b64 s55, vcc
    s_max_i32 s55, s55, 0
    v_mov_b32 v31, 0xff800000
    v_cmp_eq_u32 vcc, s55, v1
    s_nop 1
    v_cndmask_b32 v28, v28, v31, vcc
    v_mov_b32 v30, v28
    s_nop 1
    v_max_f32_dpp v30, v30, v30 quad_perm:[1,0,3,2] row_mask:0xf bank_mask:0xf
    s_nop 1
    v_max_f32_dpp v30, v30, v30 quad_perm:[2,3,0,1] row_mask:0xf bank_mask:0xf
    s_nop 1
    v_max_f32_dpp v30, v30, v30 row_half_mirror row_mask:0xf bank_mask:0xf
    s_nop 1
    v_max_f32_dpp v30, v30, v30 row_mirror row_mask:0xf bank_mask:0xf
    v_mov_b32 v31, v30
    s_nop 1
    v_permlane16_swap_b32 v31, v30
    v_max_f32 v30, v30, v31
    v_mov_b32 v31, v30
    s_nop 1
    v_permlane32_swap_b32 v31, v30
    v_max_f32 v30, v30, v31
    v_cmp_eq_f32 vcc, v30, v28
    v_readfirstlane_b32 s101, v30
    s_ff1_i32_b64 s56, vcc
    s_max_i32 s56, s56, 0
    s_nop 3
    v_readlane_b32 s98, v29, s55
    v_readlane_b32 s99, v29, s56
    v_lshrrev_b32 v2, 4, v1
    v_and_b32 v3, 15, v1
    v_lshlrev_b32 v2, 14, v2
    v_lshl_add_u32 v2, v3, 4, v2
    s_and_b32 s30, s55, 31
    s_lshl_b32 s30, s30, 17
    s_lshr_b32 s31, s55, 5
    s_lshl_b32 s31, s31, 8
    s_add_u32 s30, s30, s31
    s_add_u32 s48, s30, 12592128
    s_and_b32 s30, s56, 31
    s_lshl_b32 s30, s30, 17
    s_lshr_b32 s31, s56, 5
    s_lshl_b32 s31, s31, 8
    s_add_u32 s30, s30, s31
    s_add_u32 s49, s30, 12592128
    v_mov_b32 v4, s98
    v_mov_b32 v5, s99
    v_mov_b32 v6, s100
    v_mov_b32 v7, s101
    v_mov_b32 v8, s55
    v_mov_b32 v9, s56
    v_mov_b32 v3, 152064
    ds_write_b128 v3, v[4:7] offset:16
    ds_write_b64 v3, v[8:9] offset:32
    s_mov_b32 s33, 400000
L_xs_53:
    buffer_load_dwordx4 v[32:35], v2, s[12:15], s48 offen sc1
    s_add_u32 s30, s48, 65536
    buffer_load_dwordx4 v[36:39], v2, s[12:15], s30 offen sc1
    buffer_load_dwordx4 v[40:43], v2, s[12:15], s49 offen sc1
    s_add_u32 s30, s49, 65536
    buffer_load_dwordx4 v[44:47], v2, s[12:15], s30 offen sc1
    s_waitcnt vmcnt(0)
    v_max_u32 v60, v32, v33
    v_max3_u32 v60, v34, v35, v60
    v_max3_u32 v60, v36, v37, v60
    v_max3_u32 v60, v38, v39, v60
    v_max3_u32 v60, v40, v41, v60
    v_max3_u32 v60, v42, v43, v60
    v_max3_u32 v60, v44, v45, v60
    v_max3_u32 v60, v46, v47, v60
    v_cmp_eq_u32 vcc, -1, v60
    s_cmp_eq_u64 vcc, 0
    s_cbranch_scc1 L_xs_53_ok
    s_sleep 1
    s_sub_u32 s33, s33, 1
    s_cmp_lg_u32 s33, 0
    s_cbranch_scc1 L_xs_53
    s_mov_b32 s54, 6
L_xs_53_ok:
    v_lshlrev_b32 v3, 4, v1
    v_add_u32 v3, 152192, v3
    ds_write_b128 v3, v[32:35]
    ds_write_b128 v3, v[36:39] offset:1024
    ds_write_b128 v3, v[40:43] offset:2048
    ds_write_b128 v3, v[44:47] offset:3072
    s_waitcnt lgkmcnt(0)
    s_branch L_bs3
L_stage:
    s_barrier
    v_lshlrev_b32 v2, 2, v0
    v_add_u32 v2, 98304, v2
    ds_read_b32 v232, v2 offset:0
    ds_read_b32 v233, v2 offset:2048
    ds_read_b32 v234, v2 offset:4096
    ds_read_b32 v235, v2 offset:6144
    ds_read_b32 v236, v2 offset:8192
    ds_read_b32 v237, v2 offset:10240
    ds_read_b32 v238, v2 offset:12288
    ds_read_b32 v239, v2 offset:14336
    s_waitcnt lgkmcnt(0)
    ds_read_b32 v240, v2 offset:16384
    ds_read_b32 v241, v2 offset:18432
    ds_read_b32 v242, v2 offset:20480
    ds_read_b32 v243, v2 offset:22528
    ds_read_b32 v244, v2 offset:24576
    ds_read_b32 v245, v2 offset:26624
    ds_read_b32 v246, v2 offset:28672
    ds_read_b32 v247, v2 offset:30720
    s_waitcnt lgkmcnt(0)
    v_lshlrev_b32 v96, 16, v232
    v_and_b32 v97, 0xffff0000, v232
    v_lshlrev_b32 v98, 16, v233
    v_and_b32 v99, 0xffff0000, v233
    v_lshlrev_b32 v100, 16, v234
    v_and_b32 v101, 0xffff0000, v234
    v_lshlrev_b32 v102, 16, v235
    v_and_b32 v103, 0xffff0000, v235
    v_lshlrev_b32 v104, 16, v236
    v_and_b32 v105, 0xffff0000, v236
    v_lshlrev_b32 v106, 16, v237
    v_and_b32 v107, 0xffff0000, v237
    v_lshlrev_b32 v108, 16, v238
    v_and_b32 v109, 0xffff0000, v238
    v_lshlrev_b32 v110, 16, v239
    v_and_b32 v111, 0xffff0000, v239
    v_lshlrev_b32 v112, 16, v240
    v_and_b32 v113, 0xffff0000, v240
    v_lshlrev_b32 v114, 16, v241
    v_and_b32 v115, 0xffff0000, v241
    v_lshlrev_b32 v116, 16, v242
    v_and_b32 v117, 0xffff0000, v242
    v_lshlrev_b32 v118, 16, v243
    v_and_b32 v119, 0xffff0000, v243
    v_lshlrev_b32 v120, 16, v244
    v_and_b32 v121, 0xffff0000, v244
    v_lshlrev_b32 v122, 16, v245
    v_and_b32 v123, 0xffff0000, v245
    v_lshlrev_b32 v124, 16, v246
    v_and_b32 v125, 0xffff0000, v246
    v_lshlrev_b32 v126, 16, v247
    v_and_b32 v127, 0xffff0000, v247
    v_lshrrev_b32 v2, 4, v1
    v_and_b32 v5, 1, v1
    v_lshlrev_b32 v5, 11, v5
    v_lshl_add_u32 v5, v2, 3, v5
    s_and_b32 s30, s34, 3
    s_lshl_b32 s31, s30, 9
    s_add_u32 s31, s31, 152192
    v_add_u32 v144, s31, v5
    v_and_b32 v3, 15, v1
    v_lshlrev_b32 v6, 6, v3
    v_lshl_add_u32 v145, v2, 4, v6
    s_lshl_b32 s42, s34, 14
    s_xor_b32 s31, s28, 4
    s_lshl_b32 s31, s31, 7
    s_add_u32 s40, s42, s31
    s_add_u32 s40, s40, 12594048
    s_add_u32 s42, s42, 12582912
    v_lshlrev_b32 v148, 4, v0
    v_lshlrev_b32 v6, 14, v2
    v_bfe_u32 v3, v1, 3, 1
    v_lshl_add_u32 v6, v3, 9, v6
    v_and_b32 v3, 7, v1
    v_lshl_add_u32 v146, v3, 4, v6
    s_lshl_b32 s31, s30, 7
    s_andn2_b32 s30, s34, 3
    s_lshl_b32 s30, s30, 14
    s_add_u32 s30, s30, s31
    s_add_u32 s41, s30, 12594048
    v_and_b32 v2, 3, v1
    v_bfe_u32 v3, v1, 2, 1
    v_lshlrev_b32 v2, 5, v2
    v_lshl_add_u32 v2, v3, 2, v2
    v_add_u32 v149, 159360, v2
    s_lshr_b32 s44, s34, 2
    v_lshrrev_b32 v2, 3, v1
    v_and_b32 v3, 7, v1
    v_lshlrev_b32 v4, 14, v2
    v_lshl_add_u32 v147, v3, 4, v4
    s_mul_i32 s43, s28, 458752
    s_lshl_b32 s30, s44, 7
    s_add_u32 s43, s43, s30
    s_add_u32 s43, s43, 12582912
    s_lshl_b32 s30, s28, 7
    s_add_u32 s30, s30, 158336
    v_lshl_add_u32 v150, v1, 4, s30
    v_and_b32 v2, 31, v1
    v_lshlrev_b32 v3, 2, v2
    v_add_u32 v151, 158336, v3
    v_lshrrev_b32 v5, 2, v2
    v_bfe_u32 v6, v2, 1, 1
    v_lshl_add_u32 v156, v5, 1, v6
    v_mov_b32 v154, 0
    v_mov_b32 v155, 0
L_bs3:
    s_barrier
    s_branch L_moe_all
L_g1_loader:
    v_lshrrev_b32 v2, 3, v1
    v_and_b32 v3, 7, v1
    v_lshrrev_b32 v4, 4, v1
    v_xor_b32 v5, v3, v4
    v_xor_b32 v6, 4, v5
    v_lshlrev_b32 v7, 11, v2
    v_lshl_add_u32 v5, v5, 4, v7
    v_lshl_add_u32 v6, v6, 4, v7
    v_add_u32 v8, 0, v5
    v_add_u32 v9, 15360, v6
    v_add_u32 v10, 30720, v5
    v_add_u32 v11, 46080, v6
    s_lshl_b32 s30, s26, 7
    s_lshl_b32 s31, s29, 5
    s_add_u32 s30, s30, s31
    s_lshl_b32 s38, s30, 11
    s_mul_i32 s39, s29, 98304
    s_lshl_b32 s30, s27, 7
    s_add_u32 s39, s39, s30
    s_lshl_b32 s30, s29, 12
    s_mul_i32 s31, s29, 6144
    s_and_b32 s37, s26, 7
    s_lshl_b32 s37, s37, 1
    s_lshr_b32 s32, s26, 3
    s_add_u32 s37, s37, s32
    s_add_u32 s40, s30, 0
    s_add_u32 s43, s31, 16384
    s_add_u32 s41, s30, 40960
    s_add_u32 s44, s31, 57344
    s_add_u32 s42, s30, 81920
    s_add_u32 s45, s31, 98304
    s_lshl_b32 s30, s37, 7
    s_add_u32 s35, s38, s30
    s_mul_i32 s30, s37, 393216
    s_add_u32 s36, s39, s30
    s_mov_b32 m0, s40
    s_add_u32 s37, s37, 1
    buffer_load_dwordx4 v8, s[4:7], s35 offen lds
    buffer_load_dwordx4 v9, s[4:7], s35 offen offset:1024 lds
    buffer_load_dwordx4 v10, s[4:7], s35 offen offset:2048 lds
    buffer_load_dwordx4 v11, s[4:7], s35 offen offset:3072 lds
    v_add_u32 v2, 0, v1
    v_mul_u32_u24 v3, 171, v2
    v_lshrrev_b32 v3, 12, v3
    v_mul_u32_u24 v4, 24, v3
    v_sub_u32 v4, v2, v4
    v_lshrrev_b32 v5, 3, v4
    v_and_b32 v4, 7, v4
    v_and_b32 v6, 2, v3
    v_lshlrev_b32 v6, 1, v6
    v_xor_b32 v4, v4, v6
    v_mul_u32_u24 v3, 6144, v3
    v_lshl_add_u32 v3, v5, 11, v3
    v_lshl_add_u32 v3, v4, 4, v3
    v_subrev_u32 v12, 0, v3
    v_add_u32 v2, 64, v1
    v_mul_u32_u24 v3, 171, v2
    v_lshrrev_b32 v3, 12, v3
    v_mul_u32_u24 v4, 24, v3
    v_sub_u32 v4, v2, v4
    v_lshrrev_b32 v5, 3, v4
    v_and_b32 v4, 7, v4
    v_and_b32 v6, 2, v3
    v_lshlrev_b32 v6, 1, v6
    v_xor_b32 v4, v4, v6
    v_mul_u32_u24 v3, 6144, v3
    v_lshl_add_u32 v3, v5, 11, v3
    v_lshl_add_u32 v3, v4, 4, v3
    v_subrev_u32 v13, 1024, v3
    v_add_u32 v2, 128, v1
    v_mul_u32_u24 v3, 171, v2
    v_lshrrev_b32 v3, 12, v3
    v_mul_u32_u24 v4, 24, v3
    v_sub_u32 v4, v2, v4
    v_lshrrev_b32 v5, 3, v4
    v_and_b32 v4, 7, v4
    v_and_b32 v6, 2, v3
    v_lshlrev_b32 v6, 1, v6
    v_xor_b32 v4, v4, v6
    v_mul_u32_u24 v3, 6144, v3
    v_lshl_add_u32 v3, v5, 11, v3
    v_lshl_add_u32 v3, v4, 4, v3
    v_subrev_u32 v14, 2048, v3
    v_add_u32 v15, 46080, v12
    v_add_u32 v16, 50176, v13
    v_add_u32 v17, 50176, v14
    s_mov_b32 m0, s43
    s_and_b32 s37, s37, 15
    buffer_load_dwordx4 v12, s[8:11], s36 offen lds
    buffer_load_dwordx4 v13, s[8:11], s36 offen offset:1024 lds
    buffer_load_dwordx4 v14, s[8:11], s36 offen offset:2048 lds
    buffer_load_dwordx4 v15, s[8:11], s36 offen offset:3072 lds
    s_add_u32 m0, m0, 0x1000
    s_nop 0
    buffer_load_dwordx4 v16, s[8:11], s36 offen lds
    buffer_load_dwordx4 v17, s[8:11], s36 offen offset:1024 lds
    s_lshl_b32 s30, s37, 7
    s_add_u32 s35, s38, s30
    s_mul_i32 s30, s37, 393216
    s_add_u32 s36, s39, s30
    s_mov_b32 m0, s41
    s_add_u32 s37, s37, 1
    buffer_load_dwordx4 v8, s[4:7], s35 offen lds
    buffer_load_dwordx4 v9, s[4:7], s35 offen offset:1024 lds
    buffer_load_dwordx4 v10, s[4:7], s35 offen offset:2048 lds
    buffer_load_dwordx4 v11, s[4:7], s35 offen offset:3072 lds
    s_mov_b32 m0, s44
    s_and_b32 s37, s37, 15
    buffer_load_dwordx4 v12, s[8:11], s36 offen lds
    buffer_load_dwordx4 v13, s[8:11], s36 offen offset:1024 lds
    buffer_load_dwordx4 v14, s[8:11], s36 offen offset:2048 lds
    buffer_load_dwordx4 v15, s[8:11], s36 offen offset:3072 lds
    s_add_u32 m0, m0, 0x1000
    s_nop 0
    buffer_load_dwordx4 v16, s[8:11], s36 offen lds
    buffer_load_dwordx4 v17, s[8:11], s36 offen offset:1024 lds
    v_lshrrev_b32 v2, 5, v1
    v_and_b32 v3, 31, v1
    v_lshlrev_b32 v4, 11, v2
    v_lshl_add_u32 v4, v3, 4, v4
    s_lshl_b32 s30, s26, 7
    s_lshl_b32 s31, s27, 3
    s_add_u32 s30, s30, s31
    s_lshl_b32 s31, s29, 1
    s_add_u32 s48, s30, s31
    s_lshl_b32 s30, s48, 11
    buffer_load_dwordx4 v[24:27], v4, s[4:7], s30 offen
    buffer_load_dwordx4 v[28:31], v4, s[4:7], s30 offen offset:512
    buffer_load_dwordx4 v[32:35], v4, s[4:7], s30 offen offset:1024
    buffer_load_dwordx4 v[36:39], v4, s[4:7], s30 offen offset:1536
    v_lshlrev_b32 v2, 2, v1
    v_add_u32 v2, 163584, v2
    v_mov_b32 v3, 0
    ds_write_b32 v2, v3
    s_waitcnt vmcnt(14) lgkmcnt(0)
    s_barrier
    v_lshrrev_b32 v2, 5, v1
    v_and_b32 v3, 31, v1
    s_mul_i32 s30, s29, 6144
    s_add_u32 s30, s30, 16384
    v_mul_u32_u24 v2, 384, v2
    v_add_u32 v2, s30, v2
    v_lshlrev_b32 v3, 2, v3
    v_xor_b32 v4, 64, v3
    v_add_u32 v3, v2, v3
    v_add_u32 v4, v2, v4
    s_lshl_b32 s30, s37, 7
    s_add_u32 s35, s38, s30
    s_mul_i32 s30, s37, 393216
    s_add_u32 s36, s39, s30
    s_mov_b32 m0, s42
    s_add_u32 s37, s37, 1
    buffer_load_dwordx4 v8, s[4:7], s35 offen lds
    ds_read_b32 v40, v3 offset:0
    ds_read_b32 v41, v3 offset:128
    ds_read_b32 v42, v3 offset:256
    buffer_load_dwordx4 v9, s[4:7], s35 offen offset:1024 lds
    ds_read_b32 v43, v4 offset:768
    ds_read_b32 v44, v4 offset:896
    ds_read_b32 v45, v4 offset:1024
    buffer_load_dwordx4 v10, s[4:7], s35 offen offset:2048 lds
    ds_read_b32 v46, v3 offset:1536
    ds_read_b32 v47, v3 offset:1664
    ds_read_b32 v48, v3 offset:1792
    buffer_load_dwordx4 v11, s[4:7], s35 offen offset:3072 lds
    ds_read_b32 v49, v4 offset:2304
    ds_read_b32 v50, v4 offset:2432
    ds_read_b32 v51, v4 offset:2560
    s_mov_b32 m0, s45
    s_and_b32 s37, s37, 15
    buffer_load_dwordx4 v12, s[8:11], s36 offen lds
    s_waitcnt lgkmcnt(0)
    ds_read_b32 v52, v3 offset:3072
    ds_read_b32 v53, v3 offset:3200
    buffer_load_dwordx4 v13, s[8:11], s36 offen offset:1024 lds
    ds_read_b32 v54, v3 offset:3328
    ds_read_b32 v55, v4 offset:3840
    ds_read_b32 v56, v4 offset:3968
    buffer_load_dwordx4 v14, s[8:11], s36 offen offset:2048 lds
    ds_read_b32 v57, v4 offset:4096
    ds_read_b32 v58, v3 offset:4608
    ds_read_b32 v59, v3 offset:4736
    buffer_load_dwordx4 v15, s[8:11], s36 offen offset:3072 lds
    ds_read_b32 v60, v3 offset:4864
    ds_read_b32 v61, v4 offset:5376
    ds_read_b32 v62, v4 offset:5504
    s_add_u32 m0, m0, 0x1000
    s_nop 0
    buffer_load_dwordx4 v16, s[8:11], s36 offen lds
    ds_read_b32 v63, v4 offset:5632
    s_waitcnt lgkmcnt(0)
    buffer_load_dwordx4 v17, s[8:11], s36 offen offset:1024 lds
    s_waitcnt vmcnt(10)
    s_barrier
    s_lshl_b32 s30, s37, 7
    s_add_u32 s35, s38, s30
    s_mul_i32 s30, s37, 393216
    s_add_u32 s36, s39, s30
    s_mov_b32 m0, s40
    s_add_u32 s37, s37, 1
    buffer_load_dwordx4 v8, s[4:7], s35 offen lds
    v_lshlrev_b32 v64, 16, v24
    v_and_b32 v65, 0xffff0000, v24
    v_lshlrev_b32 v66, 16, v25
    v_and_b32 v67, 0xffff0000, v25
    v_lshlrev_b32 v68, 16, v26
    v_and_b32 v69, 0xffff0000, v26
    v_lshlrev_b32 v70, 16, v27
    v_and_b32 v71, 0xffff0000, v27
    buffer_load_dwordx4 v9, s[4:7], s35 offen offset:1024 lds
    v_lshlrev_b32 v72, 16, v28
    v_and_b32 v73, 0xffff0000, v28
    v_lshlrev_b32 v74, 16, v29
    v_and_b32 v75, 0xffff0000, v29
    v_lshlrev_b32 v76, 16, v30
    v_and_b32 v77, 0xffff0000, v30
    v_lshlrev_b32 v78, 16, v31
    v_and_b32 v79, 0xffff0000, v31
    buffer_load_dwordx4 v10, s[4:7], s35 offen offset:2048 lds
    v_lshlrev_b32 v80, 16, v32
    v_and_b32 v81, 0xffff0000, v32
    v_lshlrev_b32 v82, 16, v33
    v_and_b32 v83, 0xffff0000, v33
    v_lshlrev_b32 v84, 16, v34
    v_and_b32 v85, 0xffff0000, v34
    v_lshlrev_b32 v86, 16, v35
    v_and_b32 v87, 0xffff0000, v35
    buffer_load_dwordx4 v11, s[4:7], s35 offen offset:3072 lds
    v_lshlrev_b32 v88, 16, v36
    v_and_b32 v89, 0xffff0000, v36
    v_lshlrev_b32 v90, 16, v37
    v_and_b32 v91, 0xffff0000, v37
    v_lshlrev_b32 v92, 16, v38
    v_and_b32 v93, 0xffff0000, v38
    v_lshlrev_b32 v94, 16, v39
    v_and_b32 v95, 0xffff0000, v39
    s_mov_b32 m0, s43
    s_and_b32 s37, s37, 15
    buffer_load_dwordx4 v12, s[8:11], s36 offen lds
    v_add_f32 v96, v64, v65
    v_add_f32 v97, v66, v67
    v_add_f32 v96, v96, v68
    v_add_f32 v97, v97, v69
    v_add_f32 v96, v96, v70
    v_add_f32 v97, v97, v71
    v_add_f32 v96, v96, v72
    v_add_f32 v97, v97, v73
    buffer_load_dwordx4 v13, s[8:11], s36 offen offset:1024 lds
    v_add_f32 v96, v96, v74
    v_add_f32 v97, v97, v75
    v_add_f32 v96, v96, v76
    v_add_f32 v97, v97, v77
    v_add_f32 v96, v96, v78
    v_add_f32 v97, v97, v79
    v_add_f32 v96, v96, v80
    v_add_f32 v97, v97, v81
    buffer_load_dwordx4 v14, s[8:11], s36 offen offset:2048 lds
    v_add_f32 v96, v96, v82
    v_add_f32 v97, v97, v83
    v_add_f32 v96, v96, v84
    v_add_f32 v97, v97, v85
    v_add_f32 v96, v96, v86
    v_add_f32 v97, v97, v87
    v_add_f32 v96, v96, v88
    v_add_f32 v97, v97, v89
    buffer_load_dwordx4 v15, s[8:11], s36 offen offset:3072 lds
    v_add_f32 v96, v96, v90
    v_add_f32 v97, v97, v91
    v_add_f32 v96, v96, v92
    v_add_f32 v97, v97, v93
    v_add_f32 v96, v96, v94
    v_add_f32 v97, v97, v95
    v_add_f32 v96, v96, v97
    s_nop 1
    s_add_u32 m0, m0, 0x1000
    s_nop 0
    buffer_load_dwordx4 v16, s[8:11], s36 offen lds
    v_add_f32_dpp v96, v96, v96 quad_perm:[1,0,3,2] row_mask:0xf bank_mask:0xf
    s_nop 1
    v_add_f32_dpp v96, v96, v96 quad_perm:[2,3,0,1] row_mask:0xf bank_mask:0xf
    s_nop 1
    v_add_f32_dpp v96, v96, v96 row_half_mirror row_mask:0xf bank_mask:0xf
    s_nop 1
    v_add_f32_dpp v96, v96, v96 row_mirror row_mask:0xf bank_mask:0xf
    v_mov_b32 v98, v96
    buffer_load_dwordx4 v17, s[8:11], s36 offen offset:1024 lds
    s_nop 1
    v_permlane16_swap_b32 v98, v96
    v_add_f32 v96, v96, v98
    v_mul_f32 v96, 0x3a800000, v96
    s_waitcnt vmcnt(10)
    s_barrier
    s_lshl_b32 s30, s37, 7
    s_add_u32 s35, s38, s30
    s_mul_i32 s30, s37, 393216
    s_add_u32 s36, s39, s30
    s_mov_b32 m0, s41
    s_add_u32 s37, s37, 1
    buffer_load_dwordx4 v8, s[4:7], s35 offen lds
    v_sub_f32 v64, v64, v96
    v_sub_f32 v65, v65, v96
    v_sub_f32 v66, v66, v96
    v_sub_f32 v67, v67, v96
    v_sub_f32 v68, v68, v96
    v_sub_f32 v69, v69, v96
    v_sub_f32 v70, v70, v96
    v_sub_f32 v71, v71, v96
    v_sub_f32 v72, v72, v96
    buffer_load_dwordx4 v9, s[4:7], s35 offen offset:1024 lds
    v_sub_f32 v73, v73, v96
    v_sub_f32 v74, v74, v96
    v_sub_f32 v75, v75, v96
    v_sub_f32 v76, v76, v96
    v_sub_f32 v77, v77, v96
    v_sub_f32 v78, v78, v96
    v_sub_f32 v79, v79, v96
    v_sub_f32 v80, v80, v96
    v_sub_f32 v81, v81, v96
    buffer_load_dwordx4 v10, s[4:7], s35 offen offset:2048 lds
    v_sub_f32 v82, v82, v96
    v_sub_f32 v83, v83, v96
    v_sub_f32 v84, v84, v96
    v_sub_f32 v85, v85, v96
    v_sub_f32 v86, v86, v96
    v_sub_f32 v87, v87, v96
    v_sub_f32 v88, v88, v96
    v_sub_f32 v89, v89, v96
    v_sub_f32 v90, v90, v96
    buffer_load_dwordx4 v11, s[4:7], s35 offen offset:3072 lds
    v_sub_f32 v91, v91, v96
    v_sub_f32 v92, v92, v96
    v_sub_f32 v93, v93, v96
    v_sub_f32 v94, v94, v96
    v_sub_f32 v95, v95, v96
    v_mul_f32 v100, v64, v64
    v_mul_f32 v101, v65, v65
    v_fmac_f32 v100, v66, v66
    v_fmac_f32 v101, v67, v67
    s_mov_b32 m0, s44
    s_and_b32 s37, s37, 15
    buffer_load_dwordx4 v12, s[8:11], s36 offen lds
    v_fmac_f32 v100, v68, v68
    v_fmac_f32 v101, v69, v69
    v_fmac_f32 v100, v70, v70
    v_fmac_f32 v101, v71, v71
    v_fmac_f32 v100, v72, v72
    v_fmac_f32 v101, v73, v73
    v_fmac_f32 v100, v74, v74
    v_fmac_f32 v101, v75, v75
    v_fmac_f32 v100, v76, v76
    buffer_load_dwordx4 v13, s[8:11], s36 offen offset:1024 lds
    v_fmac_f32 v101, v77, v77
    v_fmac_f32 v100, v78, v78
    v_fmac_f32 v101, v79, v79
    v_fmac_f32 v100, v80, v80
    v_fmac_f32 v101, v81, v81
    v_fmac_f32 v100, v82, v82
    v_fmac_f32 v101, v83, v83
    v_fmac_f32 v100, v84, v84
    v_fmac_f32 v101, v85, v85
    buffer_load_dwordx4 v14, s[8:11], s36 offen offset:2048 lds
    v_fmac_f32 v100, v86, v86
    v_fmac_f32 v101, v87, v87
    v_fmac_f32 v100, v88, v88
    v_fmac_f32 v101, v89, v89
    v_fmac_f32 v100, v90, v90
    v_fmac_f32 v101, v91, v91
    v_fmac_f32 v100, v92, v92
    v_fmac_f32 v101, v93, v93
    v_fmac_f32 v100, v94, v94
    buffer_load_dwordx4 v15, s[8:11], s36 offen offset:3072 lds
    v_fmac_f32 v101, v95, v95
    v_add_f32 v100, v100, v101
    s_nop 1
    v_add_f32_dpp v100, v100, v100 quad_perm:[1,0,3,2] row_mask:0xf bank_mask:0xf
    s_nop 1
    v_add_f32_dpp v100, v100, v100 quad_perm:[2,3,0,1] row_mask:0xf bank_mask:0xf
    s_nop 1
    v_add_f32_dpp v100, v100, v100 row_half_mirror row_mask:0xf bank_mask:0xf
    s_nop 1
    s_add_u32 m0, m0, 0x1000
    s_nop 0
    buffer_load_dwordx4 v16, s[8:11], s36 offen lds
    v_add_f32_dpp v100, v100, v100 row_mirror row_mask:0xf bank_mask:0xf
    v_mov_b32 v98, v100
    s_nop 1
    v_permlane16_swap_b32 v98, v100
    v_add_f32 v100, v100, v98
    v_mov_b32 v98, 0x3727c5ac
    v_fmac_f32 v98, 0x3a800000, v100
    v_rsq_f32 v97, v98
    v_lshrrev_b32 v2, 5, v1
    buffer_load_dwordx4 v17, s[8:11], s36 offen offset:1024 lds
    s_lshl_b32 s30, s48, 3
    s_add_u32 s30, s30, 16777216
    v_lshlrev_b32 v2, 3, v2
    v_and_b32 v3, 31, v1
    v_cmp_eq_u32 vcc, 0, v3
    s_and_saveexec_b64 s[46:47], vcc
    buffer_store_dwordx2 v[96:97], v2, s[12:15], s30 offen sc1
    s_mov_b64 exec, s[46:47]
    s_waitcnt vmcnt(11)
    s_barrier
    s_lshl_b32 s30, s37, 7
    s_add_u32 s35, s38, s30
    s_mul_i32 s30, s37, 393216
    s_add_u32 s36, s39, s30
    s_mov_b32 m0, s42
    s_add_u32 s37, s37, 1
    buffer_load_dwordx4 v8, s[4:7], s35 offen lds
    v_lshlrev_b32 v104, 16, v40
    v_and_b32 v105, 0xffff0000, v40
    v_lshlrev_b32 v106, 16, v41
    v_and_b32 v107, 0xffff0000, v41
    v_lshlrev_b32 v108, 16, v42
    buffer_load_dwordx4 v9, s[4:7], s35 offen offset:1024 lds
    v_and_b32 v109, 0xffff0000, v42
    v_lshlrev_b32 v112, 16, v43
    v_and_b32 v113, 0xffff0000, v43
    v_lshlrev_b32 v114, 16, v44
    v_and_b32 v115, 0xffff0000, v44
    buffer_load_dwordx4 v10, s[4:7], s35 offen offset:2048 lds
    v_lshlrev_b32 v116, 16, v45
    v_and_b32 v117, 0xffff0000, v45
    v_add_f32 v104, v104, v112
    v_add_f32 v105, v105, v113
    v_add_f32 v106, v106, v114
    buffer_load_dwordx4 v11, s[4:7], s35 offen offset:3072 lds
    v_add_f32 v107, v107, v115
    v_add_f32 v108, v108, v116
    v_add_f32 v109, v109, v117
    v_lshlrev_b32 v112, 16, v46
    v_and_b32 v113, 0xffff0000, v46
    s_mov_b32 m0, s45
    s_and_b32 s37, s37, 15
    buffer_load_dwordx4 v12, s[8:11], s36 offen lds
    v_lshlrev_b32 v114, 16, v47
    v_and_b32 v115, 0xffff0000, v47
    v_lshlrev_b32 v116, 16, v48
    v_and_b32 v117, 0xffff0000, v48
    v_add_f32 v104, v104, v112
    buffer_load_dwordx4 v13, s[8:11], s36 offen offset:1024 lds
    v_add_f32 v105, v105, v113
    v_add_f32 v106, v106, v114
    v_add_f32 v107, v107, v115
    v_add_f32 v108, v108, v116
    v_add_f32 v109, v109, v117
    buffer_load_dwordx4 v14, s[8:11], s36 offen offset:2048 lds
    v_lshlrev_b32 v112, 16, v49
    v_and_b32 v113, 0xffff0000, v49
    v_lshlrev_b32 v114, 16, v50
    v_and_b32 v115, 0xffff0000, v50
    v_lshlrev_b32 v116, 16, v51
    buffer_load_dwordx4 v15, s[8:11], s36 offen offset:3072 lds
    v_and_b32 v117, 0xffff0000, v51
    v_add_f32 v104, v104, v112
    v_add_f32 v105, v105, v113
    v_add_f32 v106, v106, v114
    v_add_f32 v107, v107, v115
    s_add_u32 m0, m0, 0x1000
    s_nop 0
    buffer_load_dwordx4 v16, s[8:11], s36 offen lds
    v_add_f32 v108, v108, v116
    v_add_f32 v109, v109, v117
    buffer_load_dwordx4 v17, s[8:11], s36 offen offset:1024 lds
    s_waitcnt vmcnt(11)
    s_barrier
    s_lshl_b32 s30, s37, 7
    s_add_u32 s35, s38, s30
    s_mul_i32 s30, s37, 393216
    s_add_u32 s36, s39, s30
    s_mov_b32 m0, s40
    s_add_u32 s37, s37, 1
    buffer_load_dwordx4 v8, s[4:7], s35 offen lds
    v_lshlrev_b32 v112, 16, v52
    v_and_b32 v113, 0xffff0000, v52
    v_lshlrev_b32 v114, 16, v53
    v_and_b32 v115, 0xffff0000, v53
    v_lshlrev_b32 v116, 16, v54
    v_and_b32 v117, 0xffff0000, v54
    buffer_load_dwordx4 v9, s[4:7], s35 offen offset:1024 lds
    v_add_f32 v104, v104, v112
    v_add_f32 v105, v105, v113
    v_add_f32 v106, v106, v114
    v_add_f32 v107, v107, v115
    v_add_f32 v108, v108, v116
    v_add_f32 v109, v109, v117
    buffer_load_dwordx4 v10, s[4:7], s35 offen offset:2048 lds
    v_lshlrev_b32 v112, 16, v55
    v_and_b32 v113, 0xffff0000, v55
    v_lshlrev_b32 v114, 16, v56
    v_and_b32 v115, 0xffff0000, v56
    v_lshlrev_b32 v116, 16, v57
    v_and_b32 v117, 0xffff0000, v57
    buffer_load_dwordx4 v11, s[4:7], s35 offen offset:3072 lds
    v_add_f32 v104, v104, v112
    v_add_f32 v105, v105, v113
    v_add_f32 v106, v106, v114
    v_add_f32 v107, v107, v115
    v_add_f32 v108, v108, v116
    v_add_f32 v109, v109, v117
    s_mov_b32 m0, s43
    s_and_b32 s37, s37, 15
    buffer_load_dwordx4 v12, s[8:11], s36 offen lds
    v_lshlrev_b32 v112, 16, v58
    v_and_b32 v113, 0xffff0000, v58
    v_lshlrev_b32 v114, 16, v59
    v_and_b32 v115, 0xffff0000, v59
    v_lshlrev_b32 v116, 16, v60
    v_and_b32 v117, 0xffff0000, v60
    buffer_load_dwordx4 v13, s[8:11], s36 offen offset:1024 lds
    v_add_f32 v104, v104, v112
    v_add_f32 v105, v105, v113
    v_add_f32 v106, v106, v114
    v_add_f32 v107, v107, v115
    v_add_f32 v108, v108, v116
    v_add_f32 v109, v109, v117
    buffer_load_dwordx4 v14, s[8:11], s36 offen offset:2048 lds
    v_lshlrev_b32 v112, 16, v61
    v_and_b32 v113, 0xffff0000, v61
    v_lshlrev_b32 v114, 16, v62
    v_and_b32 v115, 0xffff0000, v62
    v_lshlrev_b32 v116, 16, v63
    v_and_b32 v117, 0xffff0000, v63
    buffer_load_dwordx4 v15, s[8:11], s36 offen offset:3072 lds
    v_add_f32 v104, v104, v112
    v_add_f32 v105, v105, v113
    v_add_f32 v106, v106, v114
    v_add_f32 v107, v107, v115
    v_add_f32 v108, v108, v116
    v_add_f32 v109, v109, v117
    s_add_u32 m0, m0, 0x1000
    s_nop 0
    buffer_load_dwordx4 v16, s[8:11], s36 offen lds
    v_and_b32 v3, 31, v1
    v_lshlrev_b32 v3, 3, v3
    v_lshrrev_b32 v2, 5, v1
    v_mul_u32_u24 v2, 768, v2
    v_add_u32 v3, v2, v3
    buffer_load_dwordx4 v17, s[8:11], s36 offen offset:1024 lds
    s_mul_i32 s30, s29, 1536
    s_add_u32 s30, s30, 155648
    v_add_u32 v3, s30, v3
    ds_write_b64 v3, v[104:105] offset:1792
    ds_write_b64 v3, v[106:107] offset:2048
    ds_write_b64 v3, v[108:109] offset:2304
    s_waitcnt vmcnt(10)
    s_barrier
    s_lshl_b32 s30, s37, 7
    s_add_u32 s35, s38, s30
    s_mul_i32 s30, s37, 393216
    s_add_u32 s36, s39, s30
    s_mov_b32 m0, s41
    s_add_u32 s37, s37, 1
    buffer_load_dwordx4 v8, s[4:7], s35 offen lds
    buffer_load_dwordx4 v9, s[4:7], s35 offen offset:1024 lds
    buffer_load_dwordx4 v10, s[4:7], s35 offen offset:2048 lds
    buffer_load_dwordx4 v11, s[4:7], s35 offen offset:3072 lds
    s_mov_b32 m0, s44
    s_and_b32 s37, s37, 15
    buffer_load_dwordx4 v12, s[8:11], s36 offen lds
    buffer_load_dwordx4 v13, s[8:11], s36 offen offset:1024 lds
    buffer_load_dwordx4 v14, s[8:11], s36 offen offset:2048 lds
    buffer_load_dwordx4 v15, s[8:11], s36 offen offset:3072 lds
    s_add_u32 m0, m0, 0x1000
    s_nop 0
    buffer_load_dwordx4 v16, s[8:11], s36 offen lds
    buffer_load_dwordx4 v17, s[8:11], s36 offen offset:1024 lds
    s_waitcnt lgkmcnt(0)
    s_waitcnt vmcnt(10)
    s_barrier
    s_mul_i32 s31, s29, 192
    v_min_u32 v3, 47, v1
    v_lshl_add_u32 v21, v3, 2, s31
    v_add_u32 v3, 155648, v21
    ds_read_b32 v64, v3 offset:1792
    ds_read_b32 v65, v3 offset:2560
    ds_read_b32 v66, v3 offset:3328
    ds_read_b32 v67, v3 offset:4096
    ds_read_b32 v68, v3 offset:4864
    ds_read_b32 v69, v3 offset:5632
    ds_read_b32 v70, v3 offset:6400
    ds_read_b32 v71, v3 offset:7168
    s_lshl_b32 s30, s37, 7
    s_add_u32 s35, s38, s30
    s_mul_i32 s30, s37, 393216
    s_add_u32 s36, s39, s30
    s_mov_b32 m0, s42
    s_add_u32 s37, s37, 1
    buffer_load_dwordx4 v8, s[4:7], s35 offen lds
    buffer_load_dwordx4 v9, s[4:7], s35 offen offset:1024 lds
    buffer_load_dwordx4 v10, s[4:7], s35 offen offset:2048 lds
    buffer_load_dwordx4 v11, s[4:7], s35 offen offset:3072 lds
    s_mov_b32 m0, s45
    s_and_b32 s37, s37, 15
    buffer_load_dwordx4 v12, s[8:11], s36 offen lds
    buffer_load_dwordx4 v13, s[8:11], s36 offen offset:1024 lds
    buffer_load_dwordx4 v14, s[8:11], s36 offen offset:2048 lds
    buffer_load_dwordx4 v15, s[8:11], s36 offen offset:3072 lds
    s_add_u32 m0, m0, 0x1000
    s_nop 0
    buffer_load_dwordx4 v16, s[8:11], s36 offen lds
    buffer_load_dwordx4 v17, s[8:11], s36 offen offset:1024 lds
    s_lshl_b32 s30, s27, 4
    s_add_u32 s30, s30, s26
    s_lshl_b32 s30, s30, 10
    s_add_u32 s30, s30, 17039360
    s_waitcnt lgkmcnt(0)
    v_add_f32 v64, v64, v65
    v_add_f32 v66, v66, v67
    v_add_f32 v68, v68, v69
    v_add_f32 v70, v70, v71
    v_add_f32 v64, v64, v66
    v_add_f32 v68, v68, v70
    v_add_f32 v64, v64, v68
    v_cmp_gt_u32 vcc, 48, v1
    s_and_saveexec_b64 s[46:47], vcc
    buffer_store_dword v64, v21, s[12:15], s30 offen sc1
    s_mov_b64 exec, s[46:47]
    v_mov_b32 v23, 0
    global_load_dword v94, v23, s[24:25] sc1
    s_waitcnt vmcnt(12)
    s_barrier
    s_lshl_b32 s30, s37, 7
    s_add_u32 s35, s38, s30
    s_mul_i32 s30, s37, 393216
    s_add_u32 s36, s39, s30
    s_mov_b32 m0, s40
    s_add_u32 s37, s37, 1
    buffer_load_dwordx4 v8, s[4:7], s35 offen lds
    buffer_load_dwordx4 v9, s[4:7], s35 offen offset:1024 lds
    buffer_load_dwordx4 v10, s[4:7], s35 offen offset:2048 lds
    buffer_load_dwordx4 v11, s[4:7], s35 offen offset:3072 lds
    s_mov_b32 m0, s43
    s_and_b32 s37, s37, 15
    buffer_load_dwordx4 v12, s[8:11], s36 offen lds
    buffer_load_dwordx4 v13, s[8:11], s36 offen offset:1024 lds
    buffer_load_dwordx4 v14, s[8:11], s36 offen offset:2048 lds
    buffer_load_dwordx4 v15, s[8:11], s36 offen offset:3072 lds
    s_add_u32 m0, m0, 0x1000
    s_nop 0
    buffer_load_dwordx4 v16, s[8:11], s36 offen lds
    buffer_load_dwordx4 v17, s[8:11], s36 offen offset:1024 lds
    s_waitcnt vmcnt(12)
    s_barrier
    s_lshl_b32 s30, s37, 7
    s_add_u32 s35, s38, s30
    s_mul_i32 s30, s37, 393216
    s_add_u32 s36, s39, s30
    s_mov_b32 m0, s41
    s_add_u32 s37, s37, 1
    buffer_load_dwordx4 v8, s[4:7], s35 offen lds
    buffer_load_dwordx4 v9, s[4:7], s35 offen offset:1024 lds
    buffer_load_dwordx4 v10, s[4:7], s35 offen offset:2048 lds
    buffer_load_dwordx4 v11, s[4:7], s35 offen offset:3072 lds
    s_mov_b32 m0, s44
    s_and_b32 s37, s37, 15
    buffer_load_dwordx4 v12, s[8:11], s36 offen lds
    buffer_load_dwordx4 v13, s[8:11], s36 offen offset:1024 lds
    buffer_load_dwordx4 v14, s[8:11], s36 offen offset:2048 lds
    buffer_load_dwordx4 v15, s[8:11], s36 offen offset:3072 lds
    s_add_u32 m0, m0, 0x1000
    s_nop 0
    buffer_load_dwordx4 v16, s[8:11], s36 offen lds
    buffer_load_dwordx4 v17, s[8:11], s36 offen offset:1024 lds
    s_waitcnt vmcnt(10)
    s_barrier
    s_lshl_b32 s30, s37, 7
    s_add_u32 s35, s38, s30
    s_mul_i32 s30, s37, 393216
    s_add_u32 s36, s39, s30
    s_mov_b32 m0, s42
    s_add_u32 s37, s37, 1
    buffer_load_dwordx4 v8, s[4:7], s35 offen lds
    buffer_load_dwordx4 v9, s[4:7], s35 offen offset:1024 lds
    buffer_load_dwordx4 v10, s[4:7], s35 offen offset:2048 lds
    buffer_load_dwordx4 v11, s[4:7], s35 offen offset:3072 lds
    s_mov_b32 m0, s45
    s_and_b32 s37, s37, 15
    buffer_load_dwordx4 v12, s[8:11], s36 offen lds
    buffer_load_dwordx4 v13, s[8:11], s36 offen offset:1024 lds
    buffer_load_dwordx4 v14, s[8:11], s36 offen offset:2048 lds
    buffer_load_dwordx4 v15, s[8:11], s36 offen offset:3072 lds
    s_add_u32 m0, m0, 0x1000
    s_nop 0
    buffer_load_dwordx4 v16, s[8:11], s36 offen lds
    buffer_load_dwordx4 v17, s[8:11], s36 offen offset:1024 lds
    s_mov_b32 s62, 400000
L_nc_54:
    v_readfirstlane_b32 s3, v94
    s_cmp_lg_u32 s3, 0
    s_cbranch_scc1 L_nc_54_ok
    s_sleep 2
    global_load_dword v94, v23, s[24:25] sc1
    s_waitcnt vmcnt(0)
    s_sub_u32 s62, s62, 1
    s_cmp_lg_u32 s62, 0
    s_cbranch_scc1 L_nc_54
    s_mov_b32 s54, 11
L_nc_54_ok:
    s_lshl_b32 s30, s34, 14
    s_add_u32 s30, s30, 12595072
    v_mov_b32 v3, s3
    v_cmp_eq_u32 vcc, 0, v1
    s_and_saveexec_b64 s[46:47], vcc
    buffer_store_dword v3, off, s[12:15], s30 sc1
    s_mov_b64 exec, s[46:47]
    s_waitcnt vmcnt(11)
    s_barrier
    s_lshl_b32 s30, s37, 7
    s_add_u32 s35, s38, s30
    s_mul_i32 s30, s37, 393216
    s_add_u32 s36, s39, s30
    s_mov_b32 m0, s40
    s_add_u32 s37, s37, 1
    buffer_load_dwordx4 v8, s[4:7], s35 offen lds
    buffer_load_dwordx4 v9, s[4:7], s35 offen offset:1024 lds
    buffer_load_dwordx4 v10, s[4:7], s35 offen offset:2048 lds
    buffer_load_dwordx4 v11, s[4:7], s35 offen offset:3072 lds
    s_mov_b32 m0, s43
    s_and_b32 s37, s37, 15
    buffer_load_dwordx4 v12, s[8:11], s36 offen lds
    buffer_load_dwordx4 v13, s[8:11], s36 offen offset:1024 lds
    buffer_load_dwordx4 v14, s[8:11], s36 offen offset:2048 lds
    buffer_load_dwordx4 v15, s[8:11], s36 offen offset:3072 lds
    s_add_u32 m0, m0, 0x1000
    s_nop 0
    buffer_load_dwordx4 v16, s[8:11], s36 offen lds
    buffer_load_dwordx4 v17, s[8:11], s36 offen offset:1024 lds
    s_waitcnt vmcnt(11)
    s_barrier
    s_lshl_b32 s30, s37, 7
    s_add_u32 s35, s38, s30
    s_mul_i32 s30, s37, 393216
    s_add_u32 s36, s39, s30
    s_mov_b32 m0, s41
    s_add_u32 s37, s37, 1
    buffer_load_dwordx4 v8, s[4:7], s35 offen lds
    buffer_load_dwordx4 v9, s[4:7], s35 offen offset:1024 lds
    buffer_load_dwordx4 v10, s[4:7], s35 offen offset:2048 lds
    buffer_load_dwordx4 v11, s[4:7], s35 offen offset:3072 lds
    s_mov_b32 m0, s44
    s_and_b32 s37, s37, 15
    buffer_load_dwordx4 v12, s[8:11], s36 offen lds
    buffer_load_dwordx4 v13, s[8:11], s36 offen offset:1024 lds
    buffer_load_dwordx4 v14, s[8:11], s36 offen offset:2048 lds
    buffer_load_dwordx4 v15, s[8:11], s36 offen offset:3072 lds
    s_add_u32 m0, m0, 0x1000
    s_nop 0
    buffer_load_dwordx4 v16, s[8:11], s36 offen lds
    buffer_load_dwordx4 v17, s[8:11], s36 offen offset:1024 lds
    s_waitcnt vmcnt(10)
    s_barrier
    v_and_b32 v3, 15, v1
    s_lshl_b32 s30, s26, 4
    v_add_u32 v2, s30, v3
    v_lshl_add_u32 v3, v3, 4, s27
    v_cmp_gt_u32 vcc, 16, v1
    s_mov_b32 s51, 12595072
    s_nop 0
    v_cndmask_b32 v22, v3, v2, vcc
    v_lshlrev_b32 v22, 14, v22
    buffer_load_dword v64, v22, s[12:15], s51 offen sc1
    s_lshl_b32 s30, s37, 7
    s_add_u32 s35, s38, s30
    s_mul_i32 s30, s37, 393216
    s_add_u32 s36, s39, s30
    s_mov_b32 m0, s42
    s_add_u32 s37, s37, 1
    buffer_load_dwordx4 v8, s[4:7], s35 offen lds
    buffer_load_dwordx4 v9, s[4:7], s35 offen offset:1024 lds
    buffer_load_dwordx4 v10, s[4:7], s35 offen offset:2048 lds
    buffer_load_dwordx4 v11, s[4:7], s35 offen offset:3072 lds
    s_mov_b32 m0, s45
    s_and_b32 s37, s37, 15
    buffer_load_dwordx4 v12, s[8:11], s36 offen lds
    buffer_load_dwordx4 v13, s[8:11], s36 offen offset:1024 lds
    buffer_load_dwordx4 v14, s[8:11], s36 offen offset:2048 lds
    buffer_load_dwordx4 v15, s[8:11], s36 offen offset:3072 lds
    s_add_u32 m0, m0, 0x1000
    s_nop 0
    buffer_load_dwordx4 v16, s[8:11], s36 offen lds
    buffer_load_dwordx4 v17, s[8:11], s36 offen offset:1024 lds
    s_waitcnt vmcnt(11)
    s_barrier
    s_lshl_b32 s30, s37, 7
    s_add_u32 s35, s38, s30
    s_mul_i32 s30, s37, 393216
    s_add_u32 s36, s39, s30
    s_mov_b32 m0, s40
    s_add_u32 s37, s37, 1
    buffer_load_dwordx4 v8, s[4:7], s35 offen lds
    buffer_load_dwordx4 v9, s[4:7], s35 offen offset:1024 lds
    buffer_load_dwordx4 v10, s[4:7], s35 offen offset:2048 lds
    buffer_load_dwordx4 v11, s[4:7], s35 offen offset:3072 lds
    s_mov_b32 m0, s43
    s_and_b32 s37, s37, 15
    buffer_load_dwordx4 v12, s[8:11], s36 offen lds
    buffer_load_dwordx4 v13, s[8:11], s36 offen offset:1024 lds
    buffer_load_dwordx4 v14, s[8:11], s36 offen offset:2048 lds
    buffer_load_dwordx4 v15, s[8:11], s36 offen offset:3072 lds
    s_add_u32 m0, m0, 0x1000
    s_nop 0
    buffer_load_dwordx4 v16, s[8:11], s36 offen lds
    buffer_load_dwordx4 v17, s[8:11], s36 offen offset:1024 lds
    s_waitcnt vmcnt(10)
    s_mov_b32 s62, 400000
L_chk_55:
    v_cmp_ne_u32 vcc, s3, v64
    s_cmp_eq_u64 vcc, 0
    s_cbranch_scc1 L_chk_55_ok
    s_sleep 2
    buffer_load_dword v64, v22, s[12:15], s51 offen sc1
    s_waitcnt vmcnt(0)
    s_sub_u32 s62, s62, 1
    s_cmp_lg_u32 s62, 0
    s_cbranch_scc1 L_chk_55
    s_mov_b32 s54, 1
L_chk_55_ok:
    s_barrier
    s_load_dwordx2 s[20:21], s[0:1], 40
    s_mov_b32 s22, 7340032
    s_mov_b32 s23, 0x20000
    v_lshrrev_b32 v2, 3, v1
    v_lshrrev_b32 v3, 4, v1
    v_and_b32 v3, 3, v3
    v_lshlrev_b32 v3, 1, v3
    v_and_b32 v4, 7, v1
    v_xor_b32 v3, v3, v4
    v_mul_u32_u24 v2, 7168, v2
    v_lshl_add_u32 v212, v3, 4, v2
    s_min_u32 s32, s34, 223
    s_and_b32 s31, s32, 3
    s_lshl_b32 s31, s31, 2
    s_add_u32 s31, s31, s29
    s_mul_i32 s63, s31, 458752
    s_lshr_b32 s31, s32, 2
    s_lshl_b32 s31, s31, 7
    s_add_u32 s63, s63, s31
    s_lshl_b32 s62, s29, 13
    s_add_u32 s62, s62, 122880
    s_waitcnt lgkmcnt(0)
    v_lshlrev_b32 v2, 4, v1
    s_lshl_b32 s30, s26, 10
    s_add_u32 s30, s30, 16777216
    buffer_load_dwordx4 v[68:71], v2, s[12:15], s30 offen sc1
    s_mul_i32 s31, s29, 192
    v_min_u32 v3, 47, v1
    v_lshl_add_u32 v3, v3, 2, s31
    s_lshl_b32 s30, s27, 14
    s_add_u32 s30, s30, 17039360
    buffer_load_dword v72, v3, s[12:15], s30 offen sc1
    buffer_load_dword v73, v3, s[12:15], s30 offen offset:1024 sc1
    buffer_load_dword v74, v3, s[12:15], s30 offen offset:2048 sc1
    buffer_load_dword v75, v3, s[12:15], s30 offen offset:3072 sc1
    s_add_u32 s30, s30, 4096
    buffer_load_dword v76, v3, s[12:15], s30 offen sc1
    buffer_load_dword v77, v3, s[12:15], s30 offen offset:1024 sc1
    buffer_load_dword v78, v3, s[12:15], s30 offen offset:2048 sc1
    buffer_load_dword v79, v3, s[12:15], s30 offen offset:3072 sc1
    s_add_u32 s30, s30, 4096
    buffer_load_dword v80, v3, s[12:15], s30 offen sc1
    buffer_load_dword v81, v3, s[12:15], s30 offen offset:1024 sc1
    buffer_load_dword v82, v3, s[12:15], s30 offen offset:2048 sc1
    buffer_load_dword v83, v3, s[12:15], s30 offen offset:3072 sc1
    s_add_u32 s30, s30, 4096
    buffer_load_dword v84, v3, s[12:15], s30 offen sc1
    buffer_load_dword v85, v3, s[12:15], s30 offen offset:1024 sc1
    buffer_load_dword v86, v3, s[12:15], s30 offen offset:2048 sc1
    buffer_load_dword v87, v3, s[12:15], s30 offen offset:3072 sc1
    s_waitcnt vmcnt(17)
    s_barrier
    s_mov_b32 m0, s62
    s_add_u32 s62, s62, 1024
    buffer_load_dwordx4 v212, s[20:23], s63 offen nt lds
    s_add_u32 s63, s63, 57344
    s_mov_b32 m0, s62
    s_add_u32 s62, s62, 1024
    buffer_load_dwordx4 v212, s[20:23], s63 offen nt lds
    s_add_u32 s63, s63, 57344
    s_mov_b32 m0, s62
    s_add_u32 s62, s62, 1024
    buffer_load_dwordx4 v212, s[20:23], s63 offen nt lds
    s_add_u32 s63, s63, 57344
    s_mov_b32 m0, s62
    s_add_u32 s62, s62, 1024
    buffer_load_dwordx4 v212, s[20:23], s63 offen nt lds
    s_add_u32 s63, s63, 57344
    s_mov_b32 m0, s62
    s_add_u32 s62, s62, 1024
    buffer_load_dwordx4 v212, s[20:23], s63 offen nt lds
    s_add_u32 s63, s63, 57344
    s_mov_b32 m0, s62
    s_add_u32 s62, s62, 1024
    buffer_load_dwordx4 v212, s[20:23], s63 offen nt lds
    s_add_u32 s63, s63, 57344
    s_mov_b32 m0, s62
    s_add_u32 s62, s62, 1024
    buffer_load_dwordx4 v212, s[20:23], s63 offen nt lds
    s_add_u32 s63, s63, 57344
    s_mov_b32 m0, s62
    s_add_u32 s62, s62, 1024
    buffer_load_dwordx4 v212, s[20:23], s63 offen nt lds
    s_add_u32 s63, s63, 57344
    s_waitcnt vmcnt(8)
    v_add_f32 v72, v72, v73
    v_add_f32 v72, v72, v74
    v_add_f32 v72, v72, v75
    v_add_f32 v72, v72, v76
    v_add_f32 v72, v72, v77
    v_add_f32 v72, v72, v78
    v_add_f32 v72, v72, v79
    v_add_f32 v72, v72, v80
    v_add_f32 v72, v72, v81
    v_add_f32 v72, v72, v82
    v_add_f32 v72, v72, v83
    v_add_f32 v72, v72, v84
    v_add_f32 v72, v72, v85
    v_add_f32 v72, v72, v86
    v_add_f32 v72, v72, v87
    v_add_u32 v3, 155648, v3
    v_cmp_gt_u32 vcc, 48, v1
    s_and_saveexec_b64 s[46:47], vcc
    ds_write_b32 v3, v72 offset:1024
    s_mov_b64 exec, s[46:47]
    s_cmp_lg_u32 s29, 0
    s_cbranch_scc1 L_stw_56
    v_lshlrev_b32 v2, 3, v1
    v_add_u32 v2, 155648, v2
    v_mov_b32 v72, v68
    v_mov_b32 v73, v70
    v_mov_b32 v74, v69
    v_mov_b32 v75, v71
    ds_write_b64 v2, v[72:73] offset:0
    ds_write_b64 v2, v[74:75] offset:512
L_stw_56:
    s_waitcnt lgkmcnt(0)
    s_barrier
    s_branch L_g1_join
L_fin:
    s_cmp_eq_u32 s54, 0
    s_cbranch_scc1 L_end
    v_mov_b32 v3, s54
    s_mov_b32 s30, 25165824
    buffer_store_dword v3, off, s[12:15], s30
L_end:
    s_endpgm

.section .rodata,"a"
.p2align 6
.amdhsa_kernel sequential_preLN__sliding_block__moe_arch_mod__prompt_kernel
  .amdhsa_next_free_vgpr 256
  .amdhsa_next_free_sgpr 102
  .amdhsa_accum_offset 256
  .amdhsa_group_segment_fixed_size 0
  .amdhsa_kernarg_size 88
  .amdhsa_user_sgpr_count 2
  .amdhsa_user_sgpr_kernarg_segment_ptr 1
  .amdhsa_system_sgpr_workgroup_id_x 1
.end_amdhsa_kernel
```
